```python
import torch

def _softmax(x, axis=-1):
    return torch.softmax(x, dim=axis)
def _gelu(x):
    return torch.nn.functional.gelu(x, approximate="tanh")
def _silu(x):
    return torch.nn.functional.silu(x)
def _sigmoid(x):
    return torch.sigmoid(x)
def _layernorm(x, axis=-1, eps=1e-5):
    m = x.mean(dim=axis, keepdim=True)
    v = x.var(dim=axis, keepdim=True, unbiased=False)
    return (x - m) / torch.sqrt(v + eps)
def _scatter_add(tgt, idx, src, axis=0):
    return tgt.clone().index_add_(axis, idx, src)
def _segment_sum(src, seg, n):
    out = torch.zeros((n,) + src.shape[1:], dtype=src.dtype)
    return out.index_add_(0, seg, src)
def _pad(x, pw):
    flat = tuple(v for pair in reversed(pw) for v in pair)
    return torch.nn.functional.pad(x, flat)

kernel_name = 'sequential_preLN__linear_kernel_hedgehog__dense_activation_mish__prompt'

def setup_inputs():

    _w = (lambda a: (lambda t: t.to(torch.bfloat16) if t.is_floating_point() else t)(torch.as_tensor(a)))
    def _A_setup():
        B, S, D, H = 1, 2048, 512, 32
        Dh = D // H
        return {
            "x": _w((lambda *s: torch.randn(*s, dtype=torch.bfloat16) * 0.05)(B, S, D)),
            "wqkv": _w((lambda *s: torch.randn(*s, dtype=torch.bfloat16) * 0.2)(D, 3 * D)),
            "w_phi": _w((lambda *s: torch.randn(*s, dtype=torch.bfloat16) * 0.2)(H, Dh, Dh) * (Dh ** -0.5)),
            "wo": _w((lambda *s: torch.randn(*s, dtype=torch.bfloat16) * 0.05)(D, D)),
        }
    _A_in = _A_setup()

    def _B_setup():
        B, S, D, F = 1, 2048, 512, 1792
        return {
            "x": _w((lambda *s: torch.randn(*s, dtype=torch.bfloat16) * 0.05)(B, S, D)),
            "w1": _w((lambda *s: torch.randn(*s, dtype=torch.bfloat16) * 1.6)(D, F) * (D ** -0.5)),
            "b1": _w((lambda *s: torch.randn(*s, dtype=torch.bfloat16) * 0.4)(F)),
            "w2": _w((lambda *s: torch.randn(*s, dtype=torch.bfloat16) * 0.1)(F, D) * (F ** -0.5)),
        }
    _B_in = _B_setup()

    return {
        "A_x": _A_in["x"],
        "A_wqkv": _A_in["wqkv"],
        "A_w_phi": _A_in["w_phi"],
        "A_wo": _A_in["wo"],
        "B_x": _B_in["x"],
        "B_w1": _B_in["w1"],
        "B_b1": _B_in["b1"],
        "B_w2": _B_in["w2"],
    }

def reference(A_x, A_wqkv, A_w_phi, A_wo, B_x, B_w1, B_b1, B_w2):
    def _A_ref(x, wqkv, w_phi, wo):
        B, S, D = x.shape
        H = 32; Dh = D // H
        qkv = (lambda x, *d: x.permute(*d))((x @ wqkv).reshape(B, S, 3, H, Dh), 2, 0, 3, 1, 4)
        q, k, v = qkv[0], qkv[1], qkv[2]
        pq = torch.einsum("bhsd,hdf->bhsf", q, w_phi)
        pk = torch.einsum("bhsd,hdf->bhsf", k, w_phi)
        phi_q = torch.concatenate([_softmax(pq, axis=-1), _softmax(-pq, axis=-1)], axis=-1)
        phi_k = torch.concatenate([_softmax(pk, axis=-1), _softmax(-pk, axis=-1)], axis=-1)
        kv = torch.einsum("bhsf,bhsd->bhfd", phi_k, v)
        z  = torch.einsum("bhsf->bhf", phi_k)
        num = torch.einsum("bhqf,bhfd->bhqd", phi_q, kv)
        den = torch.einsum("bhqf,bhf->bhq", phi_q, z)[..., None] + 1e-6
        o = num / den
        return (lambda x, *d: x.permute(*d))(o, 0, 2, 1, 3).reshape(B, S, D) @ wo

    def _B_ref(x, w1, b1, w2):
        h = torch.einsum("bsd,df->bsf", x, w1) + b1
        sp = torch.log1p(torch.exp(-torch.abs(h))) + torch.where(h > 0, h, torch.zeros_like(h))
        act = h * torch.tanh(sp)
        return torch.einsum("bsf,fd->bsd", act, w2)

    x = A_x
    h = x + _A_ref(_layernorm(x, axis=-1), A_wqkv, A_w_phi, A_wo)
    h2 = h + _B_ref(_layernorm(h, axis=-1), B_w1, B_b1, B_w2)
    return h2
```

```asm
; @launch grid=(256,1,1) block=(256,1,1) lds=163840
.amdgcn_target "amdgcn-amd-amdhsa--gfx950"
.text
.globl sequential_preLN__linear_kernel_hedgehog__dense_activation_mish__prompt_kernel
.p2align 8
.type sequential_preLN__linear_kernel_hedgehog__dense_activation_mish__prompt_kernel,@function
sequential_preLN__linear_kernel_hedgehog__dense_activation_mish__prompt_kernel:
    s_cmp_ge_u32 s2, 256
    s_cbranch_scc1 L_end
    s_load_dwordx2 s[4:5], s[0:1], 0
    s_load_dwordx2 s[8:9], s[0:1], 8
    s_load_dwordx2 s[28:29], s[0:1], 80
    s_getpc_b64 s[32:33]
L_pc:
    s_and_b32 s3, s2, 0xf8
    v_lshrrev_b32 v248, 5, v0
    v_add_lshl_u32 v250, v248, s3, 7
    v_min_u32 v250, L_end-L_pc, v250
    v_mov_b32 v251, 0
    v_lshl_add_u64 v[250:251], v[250:251], 0, s[32:33]
    global_load_dword v253, v[250:251], off
    s_and_b32 s32, s2, 7
    s_lshr_b32 s3, s2, 3
    s_lshl_b32 s32, s32, 5
    s_add_u32 s3, s3, s32
    v_lshl_add_u32 v248, s3, 3, v248
    v_and_b32 v249, 31, v0
    v_lshlrev_b32 v248, 10, v248
    s_mul_i32 s3, s2, 6144
    v_lshl_add_u32 v248, v249, 4, v248
    v_mad_u32_u24 v249, v0, 24, s3
    s_mov_b32 s6, 2097152
    s_mov_b32 s7, 0x20000
    s_mov_b32 s10, 1572864
    s_mov_b32 s11, 0x20000
    s_waitcnt lgkmcnt(0)
    buffer_load_dwordx4 v[4:7], v248, s[4:7], 0 offen
    buffer_load_dwordx4 v[8:11], v248, s[4:7], 0 offen offset:512
    buffer_load_dword v254, v249, s[8:11], 0 offen
    s_load_dword s34, s[28:29], 0
    s_load_dwordx2 s[12:13], s[0:1], 16
    s_load_dwordx2 s[16:17], s[0:1], 24
    s_load_dwordx2 s[20:21], s[0:1], 40
    s_load_dwordx2 s[24:25], s[0:1], 56
    v_lshrrev_b32 v243, 6, v0
    v_and_b32 v252, 63, v0
    v_readfirstlane_b32 s3, v243
    s_bfe_u32 s32, s2, 0x40003
    s_and_b32 s41, s2, 7
    s_lshr_b32 s42, s2, 7
    s_lshl1_add_u32 s35, s41, s42
    s_bfe_u32 s36, s2, 65539
    s_lshl_b32 s36, s36, 2
    s_bfe_u32 s43, s2, 196608
    s_xor_b32 s36, s36, s43
    s_lshr_b32 s42, s32, 3
    s_lshl1_add_u32 s40, s35, s42
    s_lshl2_add_u32 s40, s40, s3
    s_lshl_b32 s40, s40, 14
    s_lshl_b32 s43, s36, 7
    s_add_u32 s40, s40, s43
    s_lshl_b32 s53, s3, 11
    s_mul_i32 s37, s3, 49152
    s_and_b32 s42, s32, 7
    s_lshl_b32 s42, s42, 7
    s_add_u32 s37, s37, s42
    v_and_b32 v245, 3, v252
    v_bfe_u32 v244, v252, 4, 1
    v_lshrrev_b32 v243, 3, v252
    v_bfe_u32 v241, v252, 2, 1
    v_xor_b32 v242, v244, v241
    v_lshl_add_u32 v242, v242, 2, v245
    v_mul_u32_u24 v241, 3072, v243
    v_lshl_add_u32 v246, v242, 4, v241
    v_add_u32 v247, 23552, v246
    v_and_b32 v242, 7, v252
    v_lshrrev_b32 v241, 1, v243
    v_xor_b32 v242, v242, v241
    v_lshlrev_b32 v243, 10, v243
    v_lshl_add_u32 v248, v242, 4, v243
    v_xor_b32 v242, 4, v242
    v_lshl_add_u32 v249, v242, 4, v243
    v_add_u32 v249, 7168, v249
    s_xor_b32 s38, s36, 0
    s_mul_i32 s38, s38, 196608
    s_add_u32 s38, s38, s37
    s_add_u32 m0, s53, 0
    s_add_u32 s38, s38, 1024
    buffer_load_dwordx4 v246, s[8:11], s38 offen lds
    buffer_load_dwordx4 v247, s[8:11], s38 offen offset:1024 lds
    s_add_u32 m0, s53, 98304
    s_add_u32 s38, s38, 1024
    buffer_load_dwordx4 v246, s[8:11], s38 offen lds
    buffer_load_dwordx4 v247, s[8:11], s38 offen offset:1024 lds
    s_add_u32 m0, s53, 131072
    s_xor_b32 s39, s40, 0
    buffer_load_dwordx4 v248, s[4:7], s39 offen lds
    buffer_load_dwordx4 v249, s[4:7], s39 offen offset:1024 lds
    v_lshrrev_b32 v243, 1, v252
    v_mul_u32_u24 v243, 3072, v243
    v_and_b32 v242, 1, v252
    v_lshl_add_u32 v243, v242, 10, v243
    s_lshr_b32 s42, s2, 3
    s_lshl2_add_u32 s42, s42, s3
    s_mul_i32 s42, s42, 12288
    s_mov_b64 exec, 0xff
    buffer_load_dword v255, v243, s[8:11], s42 offen offset:1408
    s_mov_b64 exec, -1
    v_lshlrev_b32 v240, 4, v252
    v_and_b32 v251, 31, v0
    v_lshrrev_b32 v250, 5, v252
    v_bfe_u32 v239, v252, 2, 2
    s_xor_b32 s54, s36, s32
    s_and_b32 s54, s54, 7
    s_lshr_b32 s57, s32, 3
    s_and_b32 s41, s3, 1
    s_lshl1_add_u32 s57, s57, s41
    s_lshr_b32 s58, s3, 1
    s_and_b32 s44, s3, 1
    v_bfe_u32 v243, v251, 1, 3
    v_xor_b32 v243, v243, v250
    v_lshlrev_b32 v242, 7, v251
    v_lshl_add_u32 v241, v243, 4, v242
    s_lshl_b32 s41, s44, 6
    v_xor_b32 v243, s41, v241
    s_lshl_b32 s43, s44, 12
    s_add_u32 s41, s43, 131072
    v_add_u32 v232, s41, v243
    v_xor_b32 v233, 32, v232
    v_xor_b32 v234, 64, v232
    v_xor_b32 v235, 96, v232
    s_and_b32 s42, s54, 3
    s_lshl_b32 s42, s42, 13
    s_add_u32 s41, s41, s42
    s_lshl_b32 s42, s58, 6
    v_xor_b32 v241, s42, v241
    v_add_u32 v236, s41, v241
    v_xor_b32 v237, 32, v236
    v_lshl_add_u32 v243, v250, 3, v239
    v_lshrrev_b32 v242, 1, v239
    v_xor_b32 v242, s58, v242
    v_lshl_add_u32 v243, v243, 1, v242
    v_lshlrev_b32 v243, 6, v243
    v_add_u32 v243, s43, v243
    v_lshl_add_u32 v242, v244, 2, v245
    v_lshl_add_u32 v228, v242, 3, v243
    v_and_b32 v242, 1, v245
    v_lshl_add_u32 v242, v242, 1, v244
    v_lshrrev_b32 v241, 1, v245
    v_lshl_add_u32 v242, v242, 1, v241
    v_lshl_add_u32 v224, v242, 3, v243
    v_add_u32 v224, 98304, v224
    v_xor_b32 v229, 2048, v228
    v_xor_b32 v225, 2048, v224
    v_xor_b32 v230, 4096, v228
    v_xor_b32 v226, 4096, v224
    v_xor_b32 v231, 6144, v228
    v_xor_b32 v227, 6144, v224
    s_mov_b32 s30, 268435456
    s_mov_b32 s31, 0x20000
    s_mov_b32 s14, 16384
    s_mov_b32 s15, 0x20000
    s_mov_b32 s22, 1835008
    s_mov_b32 s23, 0x20000
    v_mov_b32 v191, 0
    s_mov_b32 s62, -1
    s_mov_b32 s63, 0
    s_mul_i32 s48, s35, 1245184
    s_xor_b32 s38, s36, 1
    s_mul_i32 s38, s38, 196608
    s_add_u32 s38, s38, s37
    s_add_u32 m0, s53, 8192
    s_add_u32 s38, s38, 1024
    buffer_load_dwordx4 v246, s[8:11], s38 offen lds
    s_add_u32 s48, s48, 4718592
    s_add_u32 s49, s48, 1130496
    s_lshr_b32 s55, s32, 2
    s_and_b32 s56, s32, 3
    v_bfe_u32 v243, v252, 2, 1
    v_cmp_eq_u32 vcc, v243, v244
    v_mov_b32 v242, 0x3f803f80
    v_lshlrev_b32 v238, 31, v243
    v_cndmask_b32 v220, 0, v242, vcc
    v_cndmask_b32 v221, 0, v242, vcc
    v_cndmask_b32 v222, 0, v242, vcc
    v_cndmask_b32 v223, 0, v242, vcc
    s_add_u32 m0, s53, 8192
    s_nop 0
    buffer_load_dwordx4 v247, s[8:11], s38 offen offset:1024 lds
    v_lshrrev_b32 v243, 16, v238
    v_or_b32 v238, v238, v243
    v_lshl_add_u32 v243, v250, 2, v239
    v_lshlrev_b32 v243, 5, v243
    v_lshrrev_b32 v241, 1, v245
    v_lshl_add_u32 v242, v244, 1, v241
    v_lshl_add_u32 v219, v242, 3, v243
    s_add_u32 s43, s53, 32768
    v_add_u32 v219, s43, v219
    v_mov_b32 v213, 0
    v_mov_b32 v209, 0
    v_mov_b32 v205, 0
    s_add_u32 m0, s53, 106496
    s_add_u32 s38, s38, 1024
    buffer_load_dwordx4 v246, s[8:11], s38 offen lds
    v_mov_b32 v214, 0
    v_mov_b32 v210, 0
    v_mov_b32 v206, 0
    v_mov_b32 v215, 0
    v_mov_b32 v211, 0
    v_mov_b32 v207, 0
    v_lshrrev_b32 v188, 3, v252
    v_bfe_u32 v178, v252, 2, 1
    v_xor_b32 v179, v244, v178
    v_lshl_add_u32 v179, v179, 2, v245
    v_mul_u32_u24 v188, 3584, v188
    v_lshl_add_u32 v180, v179, 4, v188
    s_add_u32 m0, s53, 106496
    s_nop 0
    buffer_load_dwordx4 v247, s[8:11], s38 offen offset:1024 lds
    v_add_u32 v181, 27648, v180
    v_add_u32 v182, 55296, v180
    v_add_u32 v183, 82944, v180
    v_lshrrev_b32 v178, 2, v252
    v_mul_u32_u24 v178, 3584, v178
    v_lshl_add_u32 v188, v245, 4, v178
    s_mul_i32 s41, s32, 224
    s_lshl_b32 s42, s56, 5
    s_add_u32 s64, s42, s41
    s_xor_b32 s42, s56, 2
    s_lshr_b32 s42, s42, 1
    s_and_b32 s43, s56, 1
    s_add_u32 m0, s53, 139264
    s_xor_b32 s39, s40, 128
    buffer_load_dwordx4 v248, s[4:7], s39 offen lds
    s_lshl2_add_u32 s42, s42, s43
    s_lshl_b32 s42, s42, 5
    s_add_u32 s65, s42, s41
    s_mul_i32 s41, s3, 114688
    s_add_u32 s67, s64, s41
    s_add_u32 s68, s65, s41
    s_lshl_b32 s70, s3, 12
    s_and_b32 s44, s3, 1
    v_lshl_add_u32 v243, v250, 6, v251
    s_lshl_b32 s41, s44, 5
    v_add_lshl_u32 v243, v243, s41, 5
    s_lshl_b32 s41, s58, 13
    s_add_u32 m0, s53, 139264
    s_nop 0
    buffer_load_dwordx4 v249, s[4:7], s39 offen offset:1024 lds
    v_add_u32 v178, s41, v243
    s_lshl_b32 s41, s58, 12
    v_add_u32 v177, s41, v243
    v_lshrrev_b32 v243, 2, v252
    v_lshlrev_b32 v242, 5, v243
    v_lshl_add_u32 v242, v245, 3, v242
    v_add_u32 v176, s70, v242
    v_add_u32 v175, s53, v242
    v_lshlrev_b32 v242, 4, v245
    v_mul_u32_u24 v174, 4224, v243
    v_add_u32 v174, v174, v242
    v_lshl_add_u32 v173, v243, 7, v242
    s_lshl_b32 s41, s58, 8
    v_lshl_add_u32 v171, v251, 3, s41
    s_lshl_b32 s41, s44, 2
    v_add_u32 v172, s41, v171
    s_lshl_b32 s41, s57, 9
    v_lshl_add_u32 v170, v251, 4, s41
    v_and_b32 v218, 15, v252
    v_lshlrev_b32 v218, 7, v218
    s_add_u32 s75, s48, 1134592
    s_and_b32 s42, s32, 7
    s_lshr_b32 s43, s32, 3
    s_lshl2_add_u32 s41, s42, s3
    s_mul_i32 s41, s41, 67584
    s_lshl1_add_u32 s44, s35, s43
    s_lshl_b32 s44, s44, 7
    s_add_u32 s41, s41, s44
    s_add_u32 s71, s41, 262144
    s_lshl1_add_u32 s41, s42, s43
    s_lshl2_add_u32 s41, s41, s3
    s_and_b32 s44, s41, 1
    s_lshr_b32 s41, s41, 1
    s_lshl4_add_u32 s41, s41, s35
    s_mul_i32 s41, s41, 4224
    s_lshl_b32 s44, s44, 6
    s_add_u32 s41, s41, s44
    s_add_u32 s72, s41, 262144
    s_and_b32 s42, s32, 7
    s_lshl1_add_u32 s42, s42, s58
    s_lshl_b32 s42, s42, 10
    v_lshlrev_b32 v169, 7, v251
    s_waitcnt lgkmcnt(0)
    s_add_u32 s47, s34, 2654435769
    v_mov_b32 v190, s47
    s_add_u32 m0, s53, 32768
    s_nop 0
    buffer_load_dwordx4 v240, s[12:15], s42 offen lds
    s_mov_b64 exec, 0xfffff
    s_waitcnt vmcnt(14)
    buffer_load_dword v254, v169, s[28:31], s49 offen sc1
    s_mov_b64 exec, -1
    v_mov_b32 v163, 0x3f803f80
    v_dot2_f32_bf16 v164, v4, v163, 0
    v_dot2_f32_bf16 v165, v4, v4, 0
    v_dot2_f32_bf16 v169, v5, v163, 0
    v_dot2_f32_bf16 v168, v5, v5, 0
    v_dot2_f32_bf16 v164, v6, v163, v164
    v_dot2_f32_bf16 v165, v6, v6, v165
    v_dot2_f32_bf16 v169, v7, v163, v169
    v_dot2_f32_bf16 v168, v7, v7, v168
    v_dot2_f32_bf16 v164, v8, v163, v164
    v_dot2_f32_bf16 v165, v8, v8, v165
    v_dot2_f32_bf16 v169, v9, v163, v169
    v_dot2_f32_bf16 v168, v9, v9, v168
    v_dot2_f32_bf16 v164, v10, v163, v164
    v_dot2_f32_bf16 v165, v10, v10, v165
    v_dot2_f32_bf16 v169, v11, v163, v169
    v_dot2_f32_bf16 v168, v11, v11, v168
    s_nop 2
    v_add_f32 v164, v164, v169
    v_add_f32 v165, v165, v168
    s_getreg_b32 s33, hwreg(HW_REG_XCC_ID, 0, 4)
    v_mov_b32 v167, s47
    v_mov_b32 v166, s33
    v_add_f32_dpp v164, v164, v164 row_ror:1 row_mask:0xf bank_mask:0xf
    v_add_f32_dpp v165, v165, v165 row_ror:1 row_mask:0xf bank_mask:0xf
    s_nop 0
    v_add_f32_dpp v164, v164, v164 row_ror:2 row_mask:0xf bank_mask:0xf
    v_add_f32_dpp v165, v165, v165 row_ror:2 row_mask:0xf bank_mask:0xf
    s_nop 0
    v_add_f32_dpp v164, v164, v164 row_ror:4 row_mask:0xf bank_mask:0xf
    v_add_f32_dpp v165, v165, v165 row_ror:4 row_mask:0xf bank_mask:0xf
    s_nop 0
    v_add_f32_dpp v164, v164, v164 row_ror:8 row_mask:0xf bank_mask:0xf
    v_add_f32_dpp v165, v165, v165 row_ror:8 row_mask:0xf bank_mask:0xf
    v_mov_b32 v169, v164
    v_mov_b32 v168, v165
    s_nop 0
    v_permlane16_swap_b32 v164, v169
    v_permlane16_swap_b32 v165, v168
    v_add_f32 v164, v164, v169
    v_add_f32 v165, v165, v168
    s_lshl2_add_u32 s41, s32, s3
    s_lshl_b32 s41, s41, 5
    s_add_u32 s41, s41, s48
    s_add_u32 s41, s41, 1134592
    v_lshlrev_b32 v169, 4, v250
    s_mov_b32 exec_lo, 1
    s_mov_b32 exec_hi, 1
    buffer_store_dwordx4 v[164:167], v169, s[28:31], s41 offen sc1
    s_mov_b64 exec, -1
    s_mul_i32 s42, s2, 2048
    v_mul_u32_u24 v169, 8, v0
    s_mov_b32 s18, 524288
    s_mov_b32 s19, 0x20000
    s_waitcnt vmcnt(9)
    buffer_load_dword v255, v169, s[16:19], s42 offen
    s_barrier
    s_cmp_eq_u32 s54, 0
    s_cbranch_scc1 L_res_1
L_resb_2:
    ds_read_b128 a[0:3], v232 offset:0
    ds_read_b64_tr_b16 v[20:21], v228 offset:0
    ds_read_b64_tr_b16 v[22:23], v228 offset:512
    ds_read_b64_tr_b16 v[24:25], v224 offset:0
    ds_read_b64_tr_b16 v[26:27], v224 offset:512
    ds_read_b128 a[4:7], v233 offset:0
    ds_read_b64_tr_b16 v[28:29], v229 offset:0
    ds_read_b64_tr_b16 v[30:31], v229 offset:512
    ds_read_b64_tr_b16 v[32:33], v225 offset:0
    ds_read_b64_tr_b16 v[34:35], v225 offset:512
    ds_read_b128 a[8:11], v234 offset:0
    ds_read_b64_tr_b16 v[36:37], v230 offset:0
    ds_read_b64_tr_b16 v[38:39], v230 offset:512
    ds_read_b64_tr_b16 v[40:41], v226 offset:0
    ds_read_b64_tr_b16 v[42:43], v226 offset:512
    ds_read_b128 a[12:15], v235 offset:0
    ds_read_b64_tr_b16 v[44:45], v231 offset:0
    ds_read_b64_tr_b16 v[46:47], v231 offset:512
    ds_read_b64_tr_b16 v[48:49], v227 offset:0
    ds_read_b64_tr_b16 v[50:51], v227 offset:512
    s_xor_b32 s38, s36, 2
    s_mul_i32 s38, s38, 196608
    s_add_u32 s38, s38, s37
    s_add_u32 m0, s53, 16384
    s_add_u32 s38, s38, 1024
    buffer_load_dwordx4 v246, s[8:11], s38 offen lds
    buffer_load_dwordx4 v247, s[8:11], s38 offen offset:1024 lds
    s_add_u32 m0, s53, 114688
    s_add_u32 s38, s38, 1024
    buffer_load_dwordx4 v246, s[8:11], s38 offen lds
    buffer_load_dwordx4 v247, s[8:11], s38 offen offset:1024 lds
    s_add_u32 m0, s53, 147456
    s_xor_b32 s39, s40, 256
    buffer_load_dwordx4 v248, s[4:7], s39 offen lds
    buffer_load_dwordx4 v249, s[4:7], s39 offen offset:1024 lds
    s_waitcnt vmcnt(10) lgkmcnt(0)
    s_barrier
    s_cmp_eq_u32 s54, 1
    s_cbranch_scc1 L_res_3
L_resb_4:
    v_mfma_f32_32x32x16_bf16 v[84:99], v[20:23], a[0:3], 0
    s_xor_b32 s38, s36, 3
    s_mul_i32 s38, s38, 196608
    s_add_u32 s38, s38, s37
    s_add_u32 m0, s53, 24576
    s_add_u32 s38, s38, 1024
    buffer_load_dwordx4 v246, s[8:11], s38 offen lds
    ds_read_b128 a[16:19], v232 offset:8192
    ds_read_b64_tr_b16 v[52:53], v228 offset:8192
    ds_read_b64_tr_b16 v[54:55], v228 offset:8704
    v_mfma_f32_32x32x16_bf16 v[100:115], v[24:27], a[0:3], 0
    buffer_load_dwordx4 v247, s[8:11], s38 offen offset:1024 lds
    ds_read_b64_tr_b16 v[56:57], v224 offset:8192
    ds_read_b64_tr_b16 v[58:59], v224 offset:8704
    ds_read_b128 a[20:23], v233 offset:8192
    v_mfma_f32_16x16x32_bf16 v[200:203], v[220:223], v[20:23], 0
    v_mfma_f32_16x16x32_bf16 v[196:199], v[220:223], v[24:27], 0
    v_mfma_f32_32x32x16_bf16 v[84:99], v[28:31], a[4:7], v[84:99]
    s_add_u32 m0, s53, 122880
    s_add_u32 s38, s38, 1024
    buffer_load_dwordx4 v246, s[8:11], s38 offen lds
    ds_read_b64_tr_b16 v[60:61], v229 offset:8192
    ds_read_b64_tr_b16 v[62:63], v229 offset:8704
    ds_read_b64_tr_b16 v[64:65], v225 offset:8192
    v_mfma_f32_32x32x16_bf16 v[100:115], v[32:35], a[4:7], v[100:115]
    buffer_load_dwordx4 v247, s[8:11], s38 offen offset:1024 lds
    ds_read_b64_tr_b16 v[66:67], v225 offset:8704
    ds_read_b128 a[24:27], v234 offset:8192
    ds_read_b64_tr_b16 v[68:69], v230 offset:8192
    v_mfma_f32_16x16x32_bf16 v[200:203], v[220:223], v[28:31], v[200:203]
    v_mfma_f32_16x16x32_bf16 v[196:199], v[220:223], v[32:35], v[196:199]
    v_mfma_f32_32x32x16_bf16 v[84:99], v[36:39], a[8:11], v[84:99]
    s_add_u32 m0, s53, 155648
    s_xor_b32 s39, s40, 384
    buffer_load_dwordx4 v248, s[4:7], s39 offen lds
    ds_read_b64_tr_b16 v[70:71], v230 offset:8704
    ds_read_b64_tr_b16 v[72:73], v226 offset:8192
    ds_read_b64_tr_b16 v[74:75], v226 offset:8704
    v_mfma_f32_32x32x16_bf16 v[100:115], v[40:43], a[8:11], v[100:115]
    buffer_load_dwordx4 v249, s[4:7], s39 offen offset:1024 lds
    ds_read_b128 a[28:31], v235 offset:8192
    ds_read_b64_tr_b16 v[76:77], v231 offset:8192
    ds_read_b64_tr_b16 v[78:79], v231 offset:8704
    v_mfma_f32_32x32x16_bf16 v[84:99], v[44:47], a[12:15], v[84:99]
    ds_read_b64_tr_b16 v[80:81], v227 offset:8192
    ds_read_b64_tr_b16 v[82:83], v227 offset:8704
    v_mfma_f32_32x32x16_bf16 v[100:115], v[48:51], a[12:15], v[100:115]
    s_mul_i32 s42, s2, 7168
    v_mul_u32_u24 v169, 28, v0
    s_mov_b32 s22, 1835008
    s_mov_b32 s23, 0x20000
    s_waitcnt vmcnt(12)
    buffer_load_dword v255, v169, s[20:23], s42 offen
    s_waitcnt vmcnt(7) lgkmcnt(0)
    s_barrier
    s_cmp_eq_u32 s54, 2
    s_cbranch_scc1 L_res_5
L_resb_6:
    v_mfma_f32_32x32x16_bf16 v[84:99], v[52:55], a[16:19], v[84:99]
    s_xor_b32 s38, s36, 4
    s_mul_i32 s38, s38, 196608
    s_add_u32 s38, s38, s37
    s_add_u32 m0, s53, 0
    s_add_u32 s38, s38, 1024
    buffer_load_dwordx4 v246, s[8:11], s38 offen lds
    ds_read_b128 a[32:35], v232 offset:16384
    ds_read_b64_tr_b16 v[20:21], v228 offset:16384
    ds_read_b64_tr_b16 v[22:23], v228 offset:16896
    v_mfma_f32_32x32x16_bf16 v[100:115], v[56:59], a[16:19], v[100:115]
    buffer_load_dwordx4 v247, s[8:11], s38 offen offset:1024 lds
    ds_read_b64_tr_b16 v[24:25], v224 offset:16384
    ds_read_b64_tr_b16 v[26:27], v224 offset:16896
    ds_read_b128 a[36:39], v233 offset:16384
    v_mfma_f32_16x16x32_bf16 v[200:203], v[220:223], v[52:55], v[200:203]
    v_mfma_f32_16x16x32_bf16 v[196:199], v[220:223], v[56:59], v[196:199]
    v_mfma_f32_32x32x16_bf16 v[84:99], v[60:63], a[20:23], v[84:99]
    s_add_u32 m0, s53, 98304
    s_add_u32 s38, s38, 1024
    buffer_load_dwordx4 v246, s[8:11], s38 offen lds
    ds_read_b64_tr_b16 v[28:29], v229 offset:16384
    ds_read_b64_tr_b16 v[30:31], v229 offset:16896
    ds_read_b64_tr_b16 v[32:33], v225 offset:16384
    v_mfma_f32_32x32x16_bf16 v[100:115], v[64:67], a[20:23], v[100:115]
    buffer_load_dwordx4 v247, s[8:11], s38 offen offset:1024 lds
    ds_read_b64_tr_b16 v[34:35], v225 offset:16896
    ds_read_b128 a[40:43], v234 offset:16384
    ds_read_b64_tr_b16 v[36:37], v230 offset:16384
    v_mfma_f32_16x16x32_bf16 v[200:203], v[220:223], v[60:63], v[200:203]
    v_mfma_f32_16x16x32_bf16 v[196:199], v[220:223], v[64:67], v[196:199]
    v_mfma_f32_32x32x16_bf16 v[84:99], v[68:71], a[24:27], v[84:99]
    s_add_u32 m0, s53, 131072
    s_xor_b32 s39, s40, 512
    buffer_load_dwordx4 v248, s[4:7], s39 offen lds
    ds_read_b64_tr_b16 v[38:39], v230 offset:16896
    ds_read_b64_tr_b16 v[40:41], v226 offset:16384
    ds_read_b64_tr_b16 v[42:43], v226 offset:16896
    v_mfma_f32_32x32x16_bf16 v[100:115], v[72:75], a[24:27], v[100:115]
    buffer_load_dwordx4 v249, s[4:7], s39 offen offset:1024 lds
    ds_read_b128 a[44:47], v235 offset:16384
    ds_read_b64_tr_b16 v[44:45], v231 offset:16384
    ds_read_b64_tr_b16 v[46:47], v231 offset:16896
    v_mfma_f32_32x32x16_bf16 v[84:99], v[76:79], a[28:31], v[84:99]
    ds_read_b64_tr_b16 v[48:49], v227 offset:16384
    ds_read_b64_tr_b16 v[50:51], v227 offset:16896
    v_mfma_f32_32x32x16_bf16 v[100:115], v[80:83], a[28:31], v[100:115]
    s_waitcnt vmcnt(7) lgkmcnt(0)
    s_barrier
    s_cmp_eq_u32 s54, 3
    s_cbranch_scc1 L_res_7
L_resb_8:
    ds_read_b64_tr_b16 v[116:117], v219 offset:0
    ds_read_b64_tr_b16 v[118:119], v219 offset:256
    ds_read_b64_tr_b16 v[120:121], v219 offset:512
    ds_read_b64_tr_b16 v[122:123], v219 offset:768
    v_mfma_f32_32x32x16_bf16 v[84:99], v[20:23], a[32:35], v[84:99]
    s_xor_b32 s38, s36, 5
    s_mul_i32 s38, s38, 196608
    s_add_u32 s38, s38, s37
    s_add_u32 m0, s53, 8192
    s_add_u32 s38, s38, 1024
    buffer_load_dwordx4 v246, s[8:11], s38 offen lds
    ds_read_b128 a[48:51], v232 offset:24576
    ds_read_b64_tr_b16 v[52:53], v228 offset:24576
    ds_read_b64_tr_b16 v[54:55], v228 offset:25088
    v_mfma_f32_32x32x16_bf16 v[100:115], v[24:27], a[32:35], v[100:115]
    buffer_load_dwordx4 v247, s[8:11], s38 offen offset:1024 lds
    ds_read_b64_tr_b16 v[56:57], v224 offset:24576
    ds_read_b64_tr_b16 v[58:59], v224 offset:25088
    ds_read_b128 a[52:55], v233 offset:24576
    v_mfma_f32_16x16x32_bf16 v[200:203], v[220:223], v[20:23], v[200:203]
    v_mfma_f32_16x16x32_bf16 v[196:199], v[220:223], v[24:27], v[196:199]
    v_mfma_f32_32x32x16_bf16 v[84:99], v[28:31], a[36:39], v[84:99]
    s_add_u32 m0, s53, 106496
    s_add_u32 s38, s38, 1024
    buffer_load_dwordx4 v246, s[8:11], s38 offen lds
    ds_read_b64_tr_b16 v[60:61], v229 offset:24576
    ds_read_b64_tr_b16 v[62:63], v229 offset:25088
    ds_read_b64_tr_b16 v[64:65], v225 offset:24576
    v_mfma_f32_32x32x16_bf16 v[100:115], v[32:35], a[36:39], v[100:115]
    buffer_load_dwordx4 v247, s[8:11], s38 offen offset:1024 lds
    ds_read_b64_tr_b16 v[66:67], v225 offset:25088
    ds_read_b128 a[56:59], v234 offset:24576
    ds_read_b64_tr_b16 v[68:69], v230 offset:24576
    v_mfma_f32_16x16x32_bf16 v[200:203], v[220:223], v[28:31], v[200:203]
    v_mfma_f32_16x16x32_bf16 v[196:199], v[220:223], v[32:35], v[196:199]
    v_mfma_f32_32x32x16_bf16 v[84:99], v[36:39], a[40:43], v[84:99]
    s_add_u32 m0, s53, 139264
    s_xor_b32 s39, s40, 640
    buffer_load_dwordx4 v248, s[4:7], s39 offen lds
    ds_read_b64_tr_b16 v[70:71], v230 offset:25088
    ds_read_b64_tr_b16 v[72:73], v226 offset:24576
    ds_read_b64_tr_b16 v[74:75], v226 offset:25088
    v_mfma_f32_32x32x16_bf16 v[100:115], v[40:43], a[40:43], v[100:115]
    buffer_load_dwordx4 v249, s[4:7], s39 offen offset:1024 lds
    ds_read_b128 a[60:63], v235 offset:24576
    ds_read_b64_tr_b16 v[76:77], v231 offset:24576
    ds_read_b64_tr_b16 v[78:79], v231 offset:25088
    v_mfma_f32_32x32x16_bf16 v[84:99], v[44:47], a[44:47], v[84:99]
    ds_read_b64_tr_b16 v[80:81], v227 offset:24576
    ds_read_b64_tr_b16 v[82:83], v227 offset:25088
    v_mfma_f32_32x32x16_bf16 v[100:115], v[48:51], a[44:47], v[100:115]
    s_waitcnt vmcnt(6) lgkmcnt(0)
    s_barrier
    s_cmp_eq_u32 s54, 4
    s_cbranch_scc1 L_res_9
L_resb_10:
    v_xor_b32 v116, v116, v238
    v_xor_b32 v117, v117, v238
    v_xor_b32 v118, v118, v238
    v_xor_b32 v119, v119, v238
    v_xor_b32 v120, v120, v238
    v_xor_b32 v121, v121, v238
    v_xor_b32 v122, v122, v238
    v_xor_b32 v123, v123, v238
    v_mfma_f32_32x32x16_bf16 v[84:99], v[52:55], a[48:51], v[84:99]
    s_xor_b32 s38, s36, 6
    s_mul_i32 s38, s38, 196608
    s_add_u32 s38, s38, s37
    s_add_u32 m0, s53, 16384
    s_add_u32 s38, s38, 1024
    buffer_load_dwordx4 v246, s[8:11], s38 offen lds
    ds_read_b128 a[64:67], v232 offset:0
    ds_read_b64_tr_b16 v[20:21], v228 offset:0
    ds_read_b64_tr_b16 v[22:23], v228 offset:512
    v_mfma_f32_32x32x16_bf16 v[100:115], v[56:59], a[48:51], v[100:115]
    buffer_load_dwordx4 v247, s[8:11], s38 offen offset:1024 lds
    ds_read_b64_tr_b16 v[24:25], v224 offset:0
    ds_read_b64_tr_b16 v[26:27], v224 offset:512
    ds_read_b128 a[68:71], v233 offset:0
    v_mfma_f32_16x16x32_bf16 v[200:203], v[220:223], v[52:55], v[200:203]
    v_mfma_f32_16x16x32_bf16 v[196:199], v[220:223], v[56:59], v[196:199]
    v_mfma_f32_32x32x16_bf16 v[84:99], v[60:63], a[52:55], v[84:99]
    s_add_u32 m0, s53, 114688
    s_add_u32 s38, s38, 1024
    buffer_load_dwordx4 v246, s[8:11], s38 offen lds
    ds_read_b64_tr_b16 v[28:29], v229 offset:0
    ds_read_b64_tr_b16 v[30:31], v229 offset:512
    ds_read_b64_tr_b16 v[32:33], v225 offset:0
    v_mfma_f32_32x32x16_bf16 v[100:115], v[64:67], a[52:55], v[100:115]
    buffer_load_dwordx4 v247, s[8:11], s38 offen offset:1024 lds
    ds_read_b64_tr_b16 v[34:35], v225 offset:512
    ds_read_b128 a[72:75], v234 offset:0
    ds_read_b64_tr_b16 v[36:37], v230 offset:0
    v_mfma_f32_16x16x32_bf16 v[200:203], v[220:223], v[60:63], v[200:203]
    v_mfma_f32_16x16x32_bf16 v[196:199], v[220:223], v[64:67], v[196:199]
    v_mfma_f32_32x32x16_bf16 v[84:99], v[68:71], a[56:59], v[84:99]
    s_add_u32 m0, s53, 147456
    s_xor_b32 s39, s40, 768
    buffer_load_dwordx4 v248, s[4:7], s39 offen lds
    ds_read_b64_tr_b16 v[38:39], v230 offset:512
    ds_read_b64_tr_b16 v[40:41], v226 offset:0
    ds_read_b64_tr_b16 v[42:43], v226 offset:512
    v_mfma_f32_32x32x16_bf16 v[100:115], v[72:75], a[56:59], v[100:115]
    buffer_load_dwordx4 v249, s[4:7], s39 offen offset:1024 lds
    ds_read_b128 a[76:79], v235 offset:0
    ds_read_b64_tr_b16 v[44:45], v231 offset:0
    ds_read_b64_tr_b16 v[46:47], v231 offset:512
    v_mfma_f32_32x32x16_bf16 v[84:99], v[76:79], a[60:63], v[84:99]
    ds_read_b64_tr_b16 v[48:49], v227 offset:0
    ds_read_b64_tr_b16 v[50:51], v227 offset:512
    v_mfma_f32_32x32x16_bf16 v[100:115], v[80:83], a[60:63], v[100:115]
    s_waitcnt vmcnt(6) lgkmcnt(0)
    s_barrier
    s_cmp_eq_u32 s54, 5
    s_cbranch_scc1 L_res_11
L_resb_12:
    v_mfma_f32_32x32x16_bf16 v[84:99], v[20:23], a[64:67], v[84:99]
    s_xor_b32 s38, s36, 7
    s_mul_i32 s38, s38, 196608
    s_add_u32 s38, s38, s37
    s_add_u32 m0, s53, 24576
    s_add_u32 s38, s38, 1024
    buffer_load_dwordx4 v246, s[8:11], s38 offen lds
    ds_read_b128 a[80:83], v232 offset:8192
    ds_read_b64_tr_b16 v[52:53], v228 offset:8192
    ds_read_b64_tr_b16 v[54:55], v228 offset:8704
    v_mfma_f32_32x32x16_bf16 v[100:115], v[24:27], a[64:67], v[100:115]
    buffer_load_dwordx4 v247, s[8:11], s38 offen offset:1024 lds
    ds_read_b64_tr_b16 v[56:57], v224 offset:8192
    ds_read_b64_tr_b16 v[58:59], v224 offset:8704
    ds_read_b128 a[84:87], v233 offset:8192
    v_mfma_f32_16x16x32_bf16 v[200:203], v[220:223], v[20:23], v[200:203]
    v_mfma_f32_16x16x32_bf16 v[196:199], v[220:223], v[24:27], v[196:199]
    v_mfma_f32_32x32x16_bf16 v[84:99], v[28:31], a[68:71], v[84:99]
    s_add_u32 m0, s53, 122880
    s_add_u32 s38, s38, 1024
    buffer_load_dwordx4 v246, s[8:11], s38 offen lds
    ds_read_b64_tr_b16 v[60:61], v229 offset:8192
    ds_read_b64_tr_b16 v[62:63], v229 offset:8704
    ds_read_b64_tr_b16 v[64:65], v225 offset:8192
    v_mfma_f32_32x32x16_bf16 v[100:115], v[32:35], a[68:71], v[100:115]
    buffer_load_dwordx4 v247, s[8:11], s38 offen offset:1024 lds
    ds_read_b64_tr_b16 v[66:67], v225 offset:8704
    ds_read_b128 a[88:91], v234 offset:8192
    ds_read_b64_tr_b16 v[68:69], v230 offset:8192
    v_mfma_f32_16x16x32_bf16 v[200:203], v[220:223], v[28:31], v[200:203]
    v_mfma_f32_16x16x32_bf16 v[196:199], v[220:223], v[32:35], v[196:199]
    v_mfma_f32_32x32x16_bf16 v[84:99], v[36:39], a[72:75], v[84:99]
    s_add_u32 m0, s53, 155648
    s_xor_b32 s39, s40, 896
    buffer_load_dwordx4 v248, s[4:7], s39 offen lds
    ds_read_b64_tr_b16 v[70:71], v230 offset:8704
    ds_read_b64_tr_b16 v[72:73], v226 offset:8192
    ds_read_b64_tr_b16 v[74:75], v226 offset:8704
    v_mfma_f32_32x32x16_bf16 v[100:115], v[40:43], a[72:75], v[100:115]
    buffer_load_dwordx4 v249, s[4:7], s39 offen offset:1024 lds
    ds_read_b128 a[92:95], v235 offset:8192
    ds_read_b64_tr_b16 v[76:77], v231 offset:8192
    ds_read_b64_tr_b16 v[78:79], v231 offset:8704
    v_mfma_f32_32x32x16_bf16 v[84:99], v[44:47], a[76:79], v[84:99]
    ds_read_b64_tr_b16 v[80:81], v227 offset:8192
    ds_read_b64_tr_b16 v[82:83], v227 offset:8704
    v_mfma_f32_32x32x16_bf16 v[100:115], v[48:51], a[76:79], v[100:115]
    s_waitcnt vmcnt(6) lgkmcnt(0)
    s_barrier
    s_cmp_eq_u32 s54, 6
    s_cbranch_scc1 L_res_13
L_resb_14:
    v_mfma_f32_32x32x16_bf16 v[84:99], v[52:55], a[80:83], v[84:99]
    s_add_u32 m0, s53, 32768
    s_xor_b32 s38, s36, 0
    s_mul_i32 s38, s38, 196608
    s_add_u32 s38, s38, s37
    buffer_load_dwordx4 v246, s[8:11], s38 offen lds
    buffer_load_dwordx4 v[192:195], v170, s[28:31], s75 offen sc1
    buffer_load_dwordx2 v[216:217], v218, s[28:31], s75 offen offset:8 sc1
    ds_read_b128 a[96:99], v232 offset:16384
    ds_read_b64_tr_b16 v[20:21], v228 offset:16384
    ds_read_b64_tr_b16 v[22:23], v228 offset:16896
    v_mfma_f32_32x32x16_bf16 v[100:115], v[56:59], a[80:83], v[100:115]
    ds_read_b64_tr_b16 v[24:25], v224 offset:16384
    ds_read_b64_tr_b16 v[26:27], v224 offset:16896
    ds_read_b128 a[100:103], v233 offset:16384
    v_mfma_f32_16x16x32_bf16 v[200:203], v[220:223], v[52:55], v[200:203]
    v_mfma_f32_16x16x32_bf16 v[196:199], v[220:223], v[56:59], v[196:199]
    v_mfma_f32_32x32x16_bf16 v[84:99], v[60:63], a[84:87], v[84:99]
    s_add_u32 m0, s53, 32768
    s_nop 0
    buffer_load_dwordx4 v247, s[8:11], s38 offen offset:1024 lds
    ds_read_b64_tr_b16 v[28:29], v229 offset:16384
    ds_read_b64_tr_b16 v[30:31], v229 offset:16896
    ds_read_b64_tr_b16 v[32:33], v225 offset:16384
    v_mfma_f32_32x32x16_bf16 v[100:115], v[64:67], a[84:87], v[100:115]
    ds_read_b64_tr_b16 v[34:35], v225 offset:16896
    ds_read_b128 a[104:107], v234 offset:16384
    ds_read_b64_tr_b16 v[36:37], v230 offset:16384
    v_mfma_f32_16x16x32_bf16 v[200:203], v[220:223], v[60:63], v[200:203]
    v_mfma_f32_16x16x32_bf16 v[196:199], v[220:223], v[64:67], v[196:199]
    v_mfma_f32_32x32x16_bf16 v[84:99], v[68:71], a[88:91], v[84:99]
    s_add_u32 m0, s53, 40960
    s_xor_b32 s38, s36, 1
    s_mul_i32 s38, s38, 196608
    s_add_u32 s38, s38, s37
    buffer_load_dwordx4 v246, s[8:11], s38 offen lds
    ds_read_b64_tr_b16 v[38:39], v230 offset:16896
    ds_read_b64_tr_b16 v[40:41], v226 offset:16384
    ds_read_b64_tr_b16 v[42:43], v226 offset:16896
    v_mfma_f32_32x32x16_bf16 v[100:115], v[72:75], a[88:91], v[100:115]
    ds_read_b128 a[108:111], v235 offset:16384
    ds_read_b64_tr_b16 v[44:45], v231 offset:16384
    ds_read_b64_tr_b16 v[46:47], v231 offset:16896
    v_mfma_f32_32x32x16_bf16 v[84:99], v[76:79], a[92:95], v[84:99]
    s_add_u32 m0, s53, 40960
    s_nop 0
    buffer_load_dwordx4 v247, s[8:11], s38 offen offset:1024 lds
    ds_read_b64_tr_b16 v[48:49], v227 offset:16384
    ds_read_b64_tr_b16 v[50:51], v227 offset:16896
    v_mfma_f32_32x32x16_bf16 v[100:115], v[80:83], a[92:95], v[100:115]
    s_waitcnt vmcnt(6) lgkmcnt(0)
    s_barrier
    s_cmp_eq_u32 s54, 7
    s_cbranch_scc1 L_res_15
L_resb_16:
    v_mfma_f32_32x32x16_bf16 v[84:99], v[20:23], a[96:99], v[84:99]
    s_add_u32 m0, s53, 49152
    s_xor_b32 s38, s36, 2
    s_mul_i32 s38, s38, 196608
    s_add_u32 s38, s38, s37
    buffer_load_dwordx4 v246, s[8:11], s38 offen lds
    ds_read_b128 a[112:115], v232 offset:24576
    ds_read_b64_tr_b16 v[52:53], v228 offset:24576
    ds_read_b64_tr_b16 v[54:55], v228 offset:25088
    v_mfma_f32_32x32x16_bf16 v[100:115], v[24:27], a[96:99], v[100:115]
    ds_read_b64_tr_b16 v[56:57], v224 offset:24576
    ds_read_b64_tr_b16 v[58:59], v224 offset:25088
    ds_read_b128 a[116:119], v233 offset:24576
    v_mfma_f32_16x16x32_bf16 v[200:203], v[220:223], v[20:23], v[200:203]
    v_mfma_f32_16x16x32_bf16 v[196:199], v[220:223], v[24:27], v[196:199]
    v_mfma_f32_32x32x16_bf16 v[84:99], v[28:31], a[100:103], v[84:99]
    s_add_u32 m0, s53, 49152
    s_nop 0
    buffer_load_dwordx4 v247, s[8:11], s38 offen offset:1024 lds
    ds_read_b64_tr_b16 v[60:61], v229 offset:24576
    ds_read_b64_tr_b16 v[62:63], v229 offset:25088
    ds_read_b64_tr_b16 v[64:65], v225 offset:24576
    v_mfma_f32_32x32x16_bf16 v[100:115], v[32:35], a[100:103], v[100:115]
    ds_read_b64_tr_b16 v[66:67], v225 offset:25088
    ds_read_b128 a[120:123], v234 offset:24576
    ds_read_b64_tr_b16 v[68:69], v230 offset:24576
    v_mfma_f32_16x16x32_bf16 v[200:203], v[220:223], v[28:31], v[200:203]
    v_mfma_f32_16x16x32_bf16 v[196:199], v[220:223], v[32:35], v[196:199]
    v_mfma_f32_32x32x16_bf16 v[84:99], v[36:39], a[104:107], v[84:99]
    s_add_u32 m0, s53, 57344
    s_xor_b32 s38, s36, 3
    s_mul_i32 s38, s38, 196608
    s_add_u32 s38, s38, s37
    buffer_load_dwordx4 v246, s[8:11], s38 offen lds
    ds_read_b64_tr_b16 v[70:71], v230 offset:25088
    ds_read_b64_tr_b16 v[72:73], v226 offset:24576
    ds_read_b64_tr_b16 v[74:75], v226 offset:25088
    v_mfma_f32_32x32x16_bf16 v[100:115], v[40:43], a[104:107], v[100:115]
    ds_read_b128 a[124:127], v235 offset:24576
    ds_read_b64_tr_b16 v[76:77], v231 offset:24576
    ds_read_b64_tr_b16 v[78:79], v231 offset:25088
    v_mfma_f32_32x32x16_bf16 v[84:99], v[44:47], a[108:111], v[84:99]
    s_add_u32 m0, s53, 57344
    s_nop 0
    buffer_load_dwordx4 v247, s[8:11], s38 offen offset:1024 lds
    ds_read_b64_tr_b16 v[80:81], v227 offset:24576
    ds_read_b64_tr_b16 v[82:83], v227 offset:25088
    v_mfma_f32_32x32x16_bf16 v[100:115], v[48:51], a[108:111], v[100:115]
    s_waitcnt lgkmcnt(14)
    v_mfma_f32_16x16x32_bf16 v[200:203], v[220:223], v[52:55], v[200:203]
    v_mfma_f32_16x16x32_bf16 v[196:199], v[220:223], v[56:59], v[196:199]
    s_waitcnt lgkmcnt(12)
    v_mfma_f32_16x16x32_bf16 v[200:203], v[220:223], v[60:63], v[200:203]
    s_waitcnt lgkmcnt(10)
    v_mfma_f32_16x16x32_bf16 v[196:199], v[220:223], v[64:67], v[196:199]
    v_mfma_f32_32x32x16_bf16 v[84:99], v[52:55], a[112:115], v[84:99]
    s_waitcnt vmcnt(8)
    v_cmp_ne_u32 vcc, s47, v195
    s_waitcnt vmcnt(7)
    v_cmp_ne_u32 s[60:61], s47, v217
    s_nop 0
    s_or_b64 vcc, vcc, s[60:61]
    s_cbranch_scc1 L_slow_17
L_back_19:
    v_cmp_ne_u32 vcc, s33, v216
    s_nop 0
    s_cmp_eq_u64 vcc, 0
    s_cselect_b32 s33, 1, 0
    v_mul_f32 v192, 0xbb000000, v192
    v_mul_f32 v193, 0x3b000000, v193
    v_cvt_pk_bf16_f32 v243, v192, v192
    v_fma_f32 v193, -v192, v192, v193
    v_and_b32 v242, 0xffff0000, v243
    v_max_f32 v193, 0, v193
    v_sub_f32 v242, v192, v242
    v_add_f32 v193, 0x3727c5ac, v193
    v_cvt_pk_bf16_f32 v242, v242, v242
    v_rsq_f32 v166, v193
    v_cndmask_b32 v208, v242, v243, s[62:63]
    v_mfma_f32_32x32x16_bf16 v[84:99], v[60:63], a[116:119], v[84:99]
    ds_write_b32 v172, v200 offset:0
    ds_write_b32 v172, v196 offset:512
    v_mul_f32 v168, 1069066811, v166
    s_waitcnt lgkmcnt(9)
    v_mfma_f32_32x32x16_bf16 v[84:99], v[68:71], a[120:123], v[84:99]
    s_waitcnt lgkmcnt(0)
    s_barrier
    ds_read_b64 v[200:201], v171 offset:0
    ds_read_b64 v[196:197], v171 offset:512
    v_mfma_f32_32x32x16_bf16 v[84:99], v[76:79], a[124:127], v[84:99]
    s_mul_i32 s42, s2, 7168
    v_mul_u32_u24 v165, 28, v0
    s_mov_b32 s26, 1835008
    s_mov_b32 s27, 0x20000
    buffer_load_dword v255, v165, s[24:27], s42 offen
    v_mfma_f32_32x32x16_bf16 v[100:115], v[56:59], a[112:115], v[100:115]
    s_waitcnt lgkmcnt(1)
    v_add_f32 v200, v200, v201
    v_cvt_pk_bf16_f32 v242, v200, v200
    v_and_b32 v242, 0xffff0000, v242
    v_sub_f32 v242, v200, v242
    v_cvt_pk_bf16_f32 v212, v200, v242
    v_mfma_f32_32x32x16_bf16 v[100:115], v[64:67], a[116:119], v[100:115]
    s_add_u32 m0, s53, 65536
    s_xor_b32 s38, s36, 4
    s_mul_i32 s38, s38, 196608
    s_add_u32 s38, s38, s37
    buffer_load_dwordx4 v246, s[8:11], s38 offen lds
    v_mfma_f32_32x32x16_bf16 v[84:99], v[212:215], v[208:211], v[84:99]
    s_waitcnt lgkmcnt(0)
    v_add_f32 v196, v196, v197
    v_cvt_pk_bf16_f32 v242, v196, v196
    v_and_b32 v242, 0xffff0000, v242
    v_sub_f32 v242, v196, v242
    v_cvt_pk_bf16_f32 v204, v196, v242
    v_mfma_f32_32x32x16_bf16 v[100:115], v[72:75], a[120:123], v[100:115]
    s_add_u32 m0, s53, 65536
    s_nop 0
    buffer_load_dwordx4 v247, s[8:11], s38 offen offset:1024 lds
    v_mfma_f32_32x32x16_bf16 v[100:115], v[80:83], a[124:127], v[100:115]
    s_nop 0
    v_cvt_pk_bf16_f32 v4, v84, v85
    v_cvt_pk_bf16_f32 v5, v86, v87
    s_add_u32 m0, s53, 73728
    s_xor_b32 s38, s36, 5
    s_mul_i32 s38, s38, 196608
    s_add_u32 s38, s38, s37
    buffer_load_dwordx4 v246, s[8:11], s38 offen lds
    v_cvt_pk_bf16_f32 v6, v88, v89
    v_cvt_pk_bf16_f32 v7, v90, v91
    v_cvt_pk_bf16_f32 v8, v92, v93
    v_cvt_pk_bf16_f32 v9, v94, v95
    v_cvt_pk_bf16_f32 v10, v96, v97
    v_cvt_pk_bf16_f32 v11, v98, v99
    v_mfma_f32_32x32x16_bf16 v[100:115], v[204:207], v[208:211], v[100:115]
    v_mfma_f32_32x32x16_bf16 v[28:43], v[116:119], v[4:7], 0
    s_add_u32 m0, s53, 73728
    s_nop 0
    buffer_load_dwordx4 v247, s[8:11], s38 offen offset:1024 lds
    v_mfma_f32_32x32x16_bf16 v[84:99], v[120:123], v[8:11], 0
    v_add_u32 v228, 32768, v228
    v_add_u32 v229, 32768, v229
    v_add_u32 v230, 32768, v230
    v_add_u32 v231, 32768, v231
    s_add_u32 m0, s53, 81920
    s_xor_b32 s38, s36, 6
    s_mul_i32 s38, s38, 196608
    s_add_u32 s38, s38, s37
    buffer_load_dwordx4 v246, s[8:11], s38 offen lds
    v_mul_f32 v100, v100, v166
    v_mul_f32 v101, v101, v166
    v_mul_f32 v102, v102, v166
    v_mul_f32 v103, v103, v166
    v_mul_f32 v104, v104, v166
    v_mul_f32 v105, v105, v166
    v_mul_f32 v106, v106, v166
    v_mul_f32 v107, v107, v166
    v_mul_f32 v108, v108, v166
    v_mul_f32 v109, v109, v166
    v_mul_f32 v110, v110, v166
    v_mul_f32 v111, v111, v166
    v_mul_f32 v112, v112, v166
    v_mul_f32 v113, v113, v166
    v_mul_f32 v114, v114, v166
    v_mul_f32 v115, v115, v166
    v_cvt_pk_bf16_f32 v20, v100, v101
    s_add_u32 m0, s53, 81920
    s_nop 0
    buffer_load_dwordx4 v247, s[8:11], s38 offen offset:1024 lds
    v_cvt_pk_bf16_f32 v21, v102, v103
    v_cvt_pk_bf16_f32 v22, v104, v105
    v_cvt_pk_bf16_f32 v23, v106, v107
    v_cvt_pk_bf16_f32 v24, v108, v109
    v_cvt_pk_bf16_f32 v25, v110, v111
    v_cvt_pk_bf16_f32 v26, v112, v113
    v_cvt_pk_bf16_f32 v27, v114, v115
    ds_write_b128 v177, v[20:23] offset:17408
    ds_write_b128 v177, v[24:27] offset:17424
    v_max3_f32 v44, v28, v29, v30
    v_max3_f32 v45, v31, v32, v33
    v_max3_f32 v48, v84, v85, v86
    v_max3_f32 v49, v87, v88, v89
    v_max3_f32 v44, v44, v34, v35
    v_max3_f32 v45, v45, v36, v37
    v_max3_f32 v48, v48, v90, v91
    v_max3_f32 v49, v49, v92, v93
    s_add_u32 m0, s53, 90112
    s_xor_b32 s38, s36, 7
    s_mul_i32 s38, s38, 196608
    s_add_u32 s38, s38, s37
    buffer_load_dwordx4 v246, s[8:11], s38 offen lds
    v_max3_f32 v44, v44, v38, v39
    v_max3_f32 v45, v45, v40, v41
    v_max3_f32 v48, v48, v94, v95
    v_max3_f32 v49, v49, v96, v97
    v_max3_f32 v44, v44, v42, v43
    v_max3_f32 v48, v48, v98, v99
    v_max_f32 v44, v44, v45
    v_max_f32 v48, v48, v49
    v_mul_f32 v44, v44, v168
    v_mul_f32 v48, v48, v168
    v_pk_fma_f32 v[28:29], v[28:29], v[168:169], v[44:45] op_sel_hi:[1,0,0] neg_lo:[0,0,1] neg_hi:[0,0,1]
    v_pk_fma_f32 v[30:31], v[30:31], v[168:169], v[44:45] op_sel_hi:[1,0,0] neg_lo:[0,0,1] neg_hi:[0,0,1]
    v_pk_fma_f32 v[32:33], v[32:33], v[168:169], v[44:45] op_sel_hi:[1,0,0] neg_lo:[0,0,1] neg_hi:[0,0,1]
    v_pk_fma_f32 v[34:35], v[34:35], v[168:169], v[44:45] op_sel_hi:[1,0,0] neg_lo:[0,0,1] neg_hi:[0,0,1]
    v_pk_fma_f32 v[36:37], v[36:37], v[168:169], v[44:45] op_sel_hi:[1,0,0] neg_lo:[0,0,1] neg_hi:[0,0,1]
    v_pk_fma_f32 v[38:39], v[38:39], v[168:169], v[44:45] op_sel_hi:[1,0,0] neg_lo:[0,0,1] neg_hi:[0,0,1]
    v_pk_fma_f32 v[40:41], v[40:41], v[168:169], v[44:45] op_sel_hi:[1,0,0] neg_lo:[0,0,1] neg_hi:[0,0,1]
    s_add_u32 m0, s53, 90112
    s_nop 0
    buffer_load_dwordx4 v247, s[8:11], s38 offen offset:1024 lds
    v_pk_fma_f32 v[42:43], v[42:43], v[168:169], v[44:45] op_sel_hi:[1,0,0] neg_lo:[0,0,1] neg_hi:[0,0,1]
    v_pk_fma_f32 v[84:85], v[84:85], v[168:169], v[48:49] op_sel_hi:[1,0,0] neg_lo:[0,0,1] neg_hi:[0,0,1]
    v_pk_fma_f32 v[86:87], v[86:87], v[168:169], v[48:49] op_sel_hi:[1,0,0] neg_lo:[0,0,1] neg_hi:[0,0,1]
    v_pk_fma_f32 v[88:89], v[88:89], v[168:169], v[48:49] op_sel_hi:[1,0,0] neg_lo:[0,0,1] neg_hi:[0,0,1]
    v_pk_fma_f32 v[90:91], v[90:91], v[168:169], v[48:49] op_sel_hi:[1,0,0] neg_lo:[0,0,1] neg_hi:[0,0,1]
    v_pk_fma_f32 v[92:93], v[92:93], v[168:169], v[48:49] op_sel_hi:[1,0,0] neg_lo:[0,0,1] neg_hi:[0,0,1]
    v_pk_fma_f32 v[94:95], v[94:95], v[168:169], v[48:49] op_sel_hi:[1,0,0] neg_lo:[0,0,1] neg_hi:[0,0,1]
    v_pk_fma_f32 v[96:97], v[96:97], v[168:169], v[48:49] op_sel_hi:[1,0,0] neg_lo:[0,0,1] neg_hi:[0,0,1]
    v_pk_fma_f32 v[98:99], v[98:99], v[168:169], v[48:49] op_sel_hi:[1,0,0] neg_lo:[0,0,1] neg_hi:[0,0,1]
    v_exp_f32 v28, v28
    v_exp_f32 v29, v29
    v_exp_f32 v30, v30
    v_exp_f32 v31, v31
    v_exp_f32 v32, v32
    v_exp_f32 v33, v33
    v_exp_f32 v34, v34
    v_exp_f32 v35, v35
    v_exp_f32 v36, v36
    v_exp_f32 v37, v37
    v_exp_f32 v38, v38
    v_exp_f32 v39, v39
    v_exp_f32 v40, v40
    s_add_u32 m0, s53, 98304
    s_nop 0
    buffer_load_dwordx4 v188, s[20:23], s68 offen lds
    v_exp_f32 v41, v41
    v_exp_f32 v42, v42
    v_exp_f32 v43, v43
    v_exp_f32 v84, v84
    v_exp_f32 v85, v85
    v_exp_f32 v86, v86
    v_exp_f32 v87, v87
    v_exp_f32 v88, v88
    v_exp_f32 v89, v89
    v_exp_f32 v90, v90
    v_exp_f32 v91, v91
    v_exp_f32 v92, v92
    v_exp_f32 v93, v93
    v_exp_f32 v94, v94
    v_exp_f32 v95, v95
    v_exp_f32 v96, v96
    v_exp_f32 v97, v97
    v_exp_f32 v98, v98
    s_add_u32 m0, s53, 99328
    s_add_u32 s45, s68, 57344
    buffer_load_dwordx4 v188, s[20:23], s45 offen lds
    v_exp_f32 v99, v99
    v_pk_add_f32 v[44:45], v[28:29], v[30:31]
    v_pk_add_f32 v[46:47], v[32:33], v[34:35]
    v_pk_add_f32 v[48:49], v[84:85], v[86:87]
    v_pk_add_f32 v[50:51], v[88:89], v[90:91]
    v_pk_add_f32 v[44:45], v[44:45], v[36:37]
    v_pk_add_f32 v[46:47], v[46:47], v[38:39]
    v_pk_add_f32 v[48:49], v[48:49], v[92:93]
    v_pk_add_f32 v[50:51], v[50:51], v[94:95]
    v_pk_add_f32 v[44:45], v[44:45], v[40:41]
    v_pk_add_f32 v[46:47], v[46:47], v[42:43]
    v_pk_add_f32 v[48:49], v[48:49], v[96:97]
    v_pk_add_f32 v[50:51], v[50:51], v[98:99]
    v_pk_add_f32 v[44:45], v[44:45], v[46:47]
    v_pk_add_f32 v[48:49], v[48:49], v[50:51]
    v_add_f32 v44, v44, v45
    v_add_f32 v48, v48, v49
    v_rcp_f32 v44, v44
    v_rcp_f32 v48, v48
    v_pk_mul_f32 v[28:29], v[28:29], v[44:45] op_sel_hi:[1,0]
    v_pk_mul_f32 v[30:31], v[30:31], v[44:45] op_sel_hi:[1,0]
    v_pk_mul_f32 v[32:33], v[32:33], v[44:45] op_sel_hi:[1,0]
    v_pk_mul_f32 v[34:35], v[34:35], v[44:45] op_sel_hi:[1,0]
    v_pk_mul_f32 v[36:37], v[36:37], v[44:45] op_sel_hi:[1,0]
    v_pk_mul_f32 v[38:39], v[38:39], v[44:45] op_sel_hi:[1,0]
    v_pk_mul_f32 v[40:41], v[40:41], v[44:45] op_sel_hi:[1,0]
    v_pk_mul_f32 v[42:43], v[42:43], v[44:45] op_sel_hi:[1,0]
    v_cvt_pk_bf16_f32 v100, v28, v29
    v_cvt_pk_bf16_f32 v101, v30, v31
    v_cvt_pk_bf16_f32 v102, v32, v33
    v_cvt_pk_bf16_f32 v103, v34, v35
    s_add_u32 m0, s53, 106496
    s_add_u32 s45, s68, 458752
    buffer_load_dwordx4 v188, s[20:23], s45 offen lds
    v_cvt_pk_bf16_f32 v104, v36, v37
    v_cvt_pk_bf16_f32 v105, v38, v39
    v_cvt_pk_bf16_f32 v106, v40, v41
    v_cvt_pk_bf16_f32 v107, v42, v43
    v_pk_mul_f32 v[84:85], v[84:85], v[48:49] op_sel_hi:[1,0]
    v_pk_mul_f32 v[86:87], v[86:87], v[48:49] op_sel_hi:[1,0]
    v_pk_mul_f32 v[88:89], v[88:89], v[48:49] op_sel_hi:[1,0]
    v_pk_mul_f32 v[90:91], v[90:91], v[48:49] op_sel_hi:[1,0]
    v_pk_mul_f32 v[92:93], v[92:93], v[48:49] op_sel_hi:[1,0]
    v_pk_mul_f32 v[94:95], v[94:95], v[48:49] op_sel_hi:[1,0]
    v_pk_mul_f32 v[96:97], v[96:97], v[48:49] op_sel_hi:[1,0]
    v_pk_mul_f32 v[98:99], v[98:99], v[48:49] op_sel_hi:[1,0]
    v_cvt_pk_bf16_f32 v108, v84, v85
    v_cvt_pk_bf16_f32 v109, v86, v87
    v_cvt_pk_bf16_f32 v110, v88, v89
    v_cvt_pk_bf16_f32 v111, v90, v91
    v_cvt_pk_bf16_f32 v112, v92, v93
    v_cvt_pk_bf16_f32 v113, v94, v95
    v_cvt_pk_bf16_f32 v114, v96, v97
    v_cvt_pk_bf16_f32 v115, v98, v99
    ds_write_b128 v178, v[100:103] offset:1024
    ds_write_b128 v178, v[104:107] offset:1040
    ds_write_b128 v178, v[108:111] offset:5120
    ds_write_b128 v178, v[112:115] offset:5136
    v_mov_b32 v20, 0x3f803f80
    v_mov_b32 v21, 0x3f803f80
    v_mov_b32 v22, 0x3f803f80
    v_mov_b32 v23, 0x3f803f80
    v_mov_b32 v127, s47
    v_mov_b32 v131, s47
    s_mov_b32 s4, 572662306
    s_mov_b32 s5, 572662306
    s_mov_b32 s6, 1145324612
    s_add_u32 m0, s53, 107520
    s_add_u32 s45, s68, 516096
    buffer_load_dwordx4 v188, s[20:23], s45 offen lds
    s_mov_b32 s7, 1145324612
    s_mov_b32 s12, 2290649224
    s_mov_b32 s13, 2290649224
    s_waitcnt vmcnt(4)
    s_waitcnt lgkmcnt(0)
    s_barrier
    ds_read_b64_tr_b16 v[68:69], v175 offset:17408
    ds_read_b64_tr_b16 v[70:71], v175 offset:17920
    ds_read_b64_tr_b16 v[52:53], v176 offset:1024
    ds_read_b64_tr_b16 v[54:55], v176 offset:1536
    ds_read_b64_tr_b16 v[60:61], v176 offset:3072
    ds_read_b64_tr_b16 v[62:63], v176 offset:3584
    ds_read_b64_tr_b16 v[72:73], v175 offset:18432
    ds_read_b64_tr_b16 v[74:75], v175 offset:18944
    ds_read_b64_tr_b16 v[56:57], v176 offset:2048
    ds_read_b64_tr_b16 v[58:59], v176 offset:2560
    ds_read_b64_tr_b16 v[64:65], v176 offset:4096
    ds_read_b64_tr_b16 v[66:67], v176 offset:4608
    s_waitcnt lgkmcnt(8)
    v_mfma_f32_16x16x32_bf16 v[196:199], v[52:55], v[20:23], 0
    v_mfma_f32_16x16x32_bf16 v[192:195], v[52:55], v[68:71], 0
    s_waitcnt lgkmcnt(6)
    v_mfma_f32_16x16x32_bf16 v[44:47], v[60:63], v[20:23], 0
    v_mfma_f32_16x16x32_bf16 v[48:51], v[60:63], v[68:71], 0
    s_waitcnt lgkmcnt(2)
    v_mfma_f32_16x16x32_bf16 v[196:199], v[56:59], v[20:23], v[196:199]
    v_mfma_f32_16x16x32_bf16 v[192:195], v[56:59], v[72:75], v[192:195]
    s_waitcnt lgkmcnt(0)
    v_mfma_f32_16x16x32_bf16 v[44:47], v[64:67], v[20:23], v[44:47]
    v_mfma_f32_16x16x32_bf16 v[48:51], v[64:67], v[72:75], v[48:51]
    ds_read_b64_tr_b16 v[52:53], v228 offset:0
    ds_read_b64_tr_b16 v[54:55], v228 offset:512
    ds_read_b64_tr_b16 v[56:57], v229 offset:0
    ds_read_b64_tr_b16 v[58:59], v229 offset:512
    ds_read_b64_tr_b16 v[60:61], v230 offset:0
    ds_read_b64_tr_b16 v[62:63], v230 offset:512
    ds_read_b64_tr_b16 v[64:65], v231 offset:0
    ds_read_b64_tr_b16 v[66:67], v231 offset:512
    v_cndmask_b32 v126, v196, v197, s[4:5]
    v_cndmask_b32 v126, v126, v198, s[6:7]
    v_cndmask_b32 v126, v126, v199, s[12:13]
    v_cvt_pk_bf16_f32 v124, v192, v193
    v_cvt_pk_bf16_f32 v125, v194, v195
    buffer_store_dwordx4 v[124:127], v174, s[28:31], s71 offen offset:0 sc1
    v_cndmask_b32 v130, v44, v45, s[4:5]
    v_cndmask_b32 v130, v130, v46, s[6:7]
    v_cndmask_b32 v130, v130, v47, s[12:13]
    v_cvt_pk_bf16_f32 v128, v48, v49
    v_cvt_pk_bf16_f32 v129, v50, v51
    buffer_store_dwordx4 v[128:131], v174, s[28:31], s71 offen offset:64 sc1
    ds_read_b64_tr_b16 v[68:69], v228 offset:8192
    ds_read_b64_tr_b16 v[70:71], v228 offset:8704
    s_waitcnt lgkmcnt(8)
    v_mfma_f32_16x16x32_bf16 v[200:203], v[220:223], v[52:55], 0
    v_mfma_f32_32x32x16_bf16 v[28:43], v[52:55], a[0:3], 0
    ds_read_b64_tr_b16 v[72:73], v229 offset:8192
    ds_read_b64_tr_b16 v[74:75], v229 offset:8704
    s_waitcnt lgkmcnt(8)
    v_mfma_f32_16x16x32_bf16 v[200:203], v[220:223], v[56:59], v[200:203]
    v_mfma_f32_32x32x16_bf16 v[28:43], v[56:59], a[4:7], v[28:43]
    ds_read_b64_tr_b16 v[76:77], v230 offset:8192
    ds_read_b64_tr_b16 v[78:79], v230 offset:8704
    s_waitcnt lgkmcnt(8)
    v_mfma_f32_32x32x16_bf16 v[28:43], v[60:63], a[8:11], v[28:43]
    ds_read_b64_tr_b16 v[80:81], v231 offset:8192
    ds_read_b64_tr_b16 v[82:83], v231 offset:8704
    s_waitcnt lgkmcnt(8)
    v_mfma_f32_32x32x16_bf16 v[28:43], v[64:67], a[12:15], v[28:43]
    ds_read_b64_tr_b16 v[52:53], v228 offset:16384
    ds_read_b64_tr_b16 v[54:55], v228 offset:16896
    s_waitcnt lgkmcnt(8)
    v_mfma_f32_16x16x32_bf16 v[200:203], v[220:223], v[68:71], v[200:203]
    v_mfma_f32_32x32x16_bf16 v[28:43], v[68:71], a[16:19], v[28:43]
    s_add_u32 m0, s53, 114688
    s_add_u32 s45, s68, 917504
    buffer_load_dwordx4 v188, s[20:23], s45 offen lds
    ds_read_b64_tr_b16 v[56:57], v229 offset:16384
    ds_read_b64_tr_b16 v[58:59], v229 offset:16896
    s_waitcnt lgkmcnt(8)
    v_mfma_f32_16x16x32_bf16 v[200:203], v[220:223], v[72:75], v[200:203]
    v_mfma_f32_32x32x16_bf16 v[28:43], v[72:75], a[20:23], v[28:43]
    ds_read_b64_tr_b16 v[60:61], v230 offset:16384
    ds_read_b64_tr_b16 v[62:63], v230 offset:16896
    s_waitcnt lgkmcnt(8)
    v_mfma_f32_32x32x16_bf16 v[28:43], v[76:79], a[24:27], v[28:43]
    ds_read_b64_tr_b16 v[64:65], v231 offset:16384
    ds_read_b64_tr_b16 v[66:67], v231 offset:16896
    s_waitcnt lgkmcnt(8)
    v_mfma_f32_32x32x16_bf16 v[28:43], v[80:83], a[28:31], v[28:43]
    ds_read_b64_tr_b16 v[68:69], v228 offset:24576
    ds_read_b64_tr_b16 v[70:71], v228 offset:25088
    s_waitcnt lgkmcnt(8)
    v_mfma_f32_16x16x32_bf16 v[200:203], v[220:223], v[52:55], v[200:203]
    v_mfma_f32_32x32x16_bf16 v[28:43], v[52:55], a[32:35], v[28:43]
    s_add_u32 m0, s53, 115712
    s_add_u32 s45, s68, 974848
    buffer_load_dwordx4 v188, s[20:23], s45 offen lds
    ds_read_b64_tr_b16 v[72:73], v229 offset:24576
    ds_read_b64_tr_b16 v[74:75], v229 offset:25088
    s_waitcnt lgkmcnt(8)
    v_mfma_f32_16x16x32_bf16 v[200:203], v[220:223], v[56:59], v[200:203]
    v_mfma_f32_32x32x16_bf16 v[28:43], v[56:59], a[36:39], v[28:43]
    ds_read_b64_tr_b16 v[76:77], v230 offset:24576
    ds_read_b64_tr_b16 v[78:79], v230 offset:25088
    s_waitcnt lgkmcnt(8)
    v_mfma_f32_32x32x16_bf16 v[28:43], v[60:63], a[40:43], v[28:43]
    ds_read_b64_tr_b16 v[80:81], v231 offset:24576
    ds_read_b64_tr_b16 v[82:83], v231 offset:25088
    s_waitcnt lgkmcnt(8)
    v_mfma_f32_32x32x16_bf16 v[28:43], v[64:67], a[44:47], v[28:43]
    ds_read_b64_tr_b16 v[52:53], v228 offset:32768
    ds_read_b64_tr_b16 v[54:55], v228 offset:33280
    s_waitcnt lgkmcnt(8)
    v_mfma_f32_16x16x32_bf16 v[200:203], v[220:223], v[68:71], v[200:203]
    v_mfma_f32_32x32x16_bf16 v[28:43], v[68:71], a[48:51], v[28:43]
    ds_read_b64_tr_b16 v[56:57], v229 offset:32768
    ds_read_b64_tr_b16 v[58:59], v229 offset:33280
    s_waitcnt lgkmcnt(8)
    v_mfma_f32_16x16x32_bf16 v[200:203], v[220:223], v[72:75], v[200:203]
    v_mfma_f32_32x32x16_bf16 v[28:43], v[72:75], a[52:55], v[28:43]
    s_add_u32 m0, s53, 122880
    s_add_u32 s45, s68, 1376256
    buffer_load_dwordx4 v188, s[20:23], s45 offen lds
    ds_read_b64_tr_b16 v[60:61], v230 offset:32768
    ds_read_b64_tr_b16 v[62:63], v230 offset:33280
    s_waitcnt lgkmcnt(8)
    v_mfma_f32_32x32x16_bf16 v[28:43], v[76:79], a[56:59], v[28:43]
    ds_read_b64_tr_b16 v[64:65], v231 offset:32768
    ds_read_b64_tr_b16 v[66:67], v231 offset:33280
    s_waitcnt lgkmcnt(8)
    v_mfma_f32_32x32x16_bf16 v[28:43], v[80:83], a[60:63], v[28:43]
    ds_read_b64_tr_b16 v[68:69], v228 offset:40960
    ds_read_b64_tr_b16 v[70:71], v228 offset:41472
    s_waitcnt lgkmcnt(8)
    v_mfma_f32_16x16x32_bf16 v[200:203], v[220:223], v[52:55], v[200:203]
    v_mfma_f32_32x32x16_bf16 v[28:43], v[52:55], a[64:67], v[28:43]
    ds_read_b64_tr_b16 v[72:73], v229 offset:40960
    ds_read_b64_tr_b16 v[74:75], v229 offset:41472
    s_waitcnt lgkmcnt(8)
    v_mfma_f32_16x16x32_bf16 v[200:203], v[220:223], v[56:59], v[200:203]
    v_mfma_f32_32x32x16_bf16 v[28:43], v[56:59], a[68:71], v[28:43]
    s_add_u32 m0, s53, 123904
    s_add_u32 s45, s68, 1433600
    buffer_load_dwordx4 v188, s[20:23], s45 offen lds
    ds_read_b64_tr_b16 v[76:77], v230 offset:40960
    ds_read_b64_tr_b16 v[78:79], v230 offset:41472
    s_waitcnt lgkmcnt(8)
    v_mfma_f32_32x32x16_bf16 v[28:43], v[60:63], a[72:75], v[28:43]
    ds_read_b64_tr_b16 v[80:81], v231 offset:40960
    ds_read_b64_tr_b16 v[82:83], v231 offset:41472
    s_waitcnt lgkmcnt(8)
    v_mfma_f32_32x32x16_bf16 v[28:43], v[64:67], a[76:79], v[28:43]
    ds_read_b64_tr_b16 v[52:53], v228 offset:49152
    ds_read_b64_tr_b16 v[54:55], v228 offset:49664
    s_waitcnt lgkmcnt(8)
    v_mfma_f32_16x16x32_bf16 v[200:203], v[220:223], v[68:71], v[200:203]
    v_mfma_f32_32x32x16_bf16 v[28:43], v[68:71], a[80:83], v[28:43]
    s_add_u32 m0, s70, 131072
    s_add_u32 s45, s67, 917504
    buffer_load_dwordx4 v180, s[20:23], s45 offen lds
    ds_read_b64_tr_b16 v[56:57], v229 offset:49152
    ds_read_b64_tr_b16 v[58:59], v229 offset:49664
    s_waitcnt lgkmcnt(8)
    v_mfma_f32_16x16x32_bf16 v[200:203], v[220:223], v[72:75], v[200:203]
    v_mfma_f32_32x32x16_bf16 v[28:43], v[72:75], a[84:87], v[28:43]
    ds_read_b64_tr_b16 v[60:61], v230 offset:49152
    ds_read_b64_tr_b16 v[62:63], v230 offset:49664
    s_waitcnt lgkmcnt(8)
    v_mfma_f32_32x32x16_bf16 v[28:43], v[76:79], a[88:91], v[28:43]
    s_add_u32 m0, s70, 131072
    s_add_u32 s45, s67, 917504
    buffer_load_dwordx4 v181, s[20:23], s45 offen offset:1024 lds
    ds_read_b64_tr_b16 v[64:65], v231 offset:49152
    ds_read_b64_tr_b16 v[66:67], v231 offset:49664
    s_waitcnt lgkmcnt(8)
    v_mfma_f32_32x32x16_bf16 v[28:43], v[80:83], a[92:95], v[28:43]
    ds_read_b64_tr_b16 v[68:69], v228 offset:57344
    ds_read_b64_tr_b16 v[70:71], v228 offset:57856
    s_waitcnt lgkmcnt(8)
    v_mfma_f32_16x16x32_bf16 v[200:203], v[220:223], v[52:55], v[200:203]
    v_mfma_f32_32x32x16_bf16 v[28:43], v[52:55], a[96:99], v[28:43]
    ds_read_b64_tr_b16 v[72:73], v229 offset:57344
    ds_read_b64_tr_b16 v[74:75], v229 offset:57856
    s_waitcnt lgkmcnt(8)
    v_mfma_f32_16x16x32_bf16 v[200:203], v[220:223], v[56:59], v[200:203]
    v_mfma_f32_32x32x16_bf16 v[28:43], v[56:59], a[100:103], v[28:43]
    ds_read_b64_tr_b16 v[76:77], v230 offset:57344
    ds_read_b64_tr_b16 v[78:79], v230 offset:57856
    s_waitcnt lgkmcnt(8)
    v_mfma_f32_32x32x16_bf16 v[28:43], v[60:63], a[104:107], v[28:43]
    ds_read_b64_tr_b16 v[80:81], v231 offset:57344
    ds_read_b64_tr_b16 v[82:83], v231 offset:57856
    s_waitcnt lgkmcnt(8)
    v_mfma_f32_32x32x16_bf16 v[28:43], v[64:67], a[108:111], v[28:43]
    s_waitcnt lgkmcnt(6)
    v_mfma_f32_16x16x32_bf16 v[200:203], v[220:223], v[68:71], v[200:203]
    v_mfma_f32_32x32x16_bf16 v[28:43], v[68:71], a[112:115], v[28:43]
    buffer_load_dwordx4 v[132:135], v173, s[28:31], s72 offen sc1
    buffer_load_dwordx4 v[136:139], v173, s[28:31], s72 offen offset:2048 sc1
    s_waitcnt lgkmcnt(4)
    v_mfma_f32_16x16x32_bf16 v[200:203], v[220:223], v[72:75], v[200:203]
    v_mfma_f32_32x32x16_bf16 v[28:43], v[72:75], a[116:119], v[28:43]
    s_waitcnt lgkmcnt(2)
    v_mfma_f32_32x32x16_bf16 v[28:43], v[76:79], a[120:123], v[28:43]
    s_nop 4
    ds_write_b32 v172, v200 offset:25600
    s_waitcnt lgkmcnt(1)
    v_mfma_f32_32x32x16_bf16 v[28:43], v[80:83], a[124:127], v[28:43]
    s_waitcnt lgkmcnt(0)
    s_barrier
    ds_read_b64 v[200:201], v171 offset:25600
    s_load_dwordx2 s[4:5], s[0:1], 48
    s_load_dwordx2 s[8:9], s[0:1], 64
    s_mov_b32 s6, 3584
    s_mov_b32 s7, 0x20000
    s_mov_b32 s10, 2097152
    s_mov_b32 s11, 0x20000
    s_mov_b32 s18, 524288
    s_mov_b32 s19, 0x20000
    s_mov_b32 s26, 1835008
    s_mov_b32 s27, 0x20000
    s_and_b32 s42, s32, 7
    s_lshr_b32 s43, s32, 3
    s_lshl2_add_u32 s41, s42, s3
    s_lshl_b32 s74, s41, 12
    s_add_u32 s74, s74, 65536
    s_lshl1_add_u32 s41, s42, s43
    s_lshl2_add_u32 s41, s41, s3
    s_lshl4_add_u32 s41, s41, s35
    s_lshl_b32 s73, s41, 7
    s_add_u32 s73, s73, 65536
    s_lshl_b32 s41, s42, 7
    s_lshl_b32 s42, s3, 17
    s_add_u32 s59, s41, s42
    s_lshl_b32 s51, s3, 14
    s_add_u32 s51, s51, 32768
    s_lshl_b32 s52, s3, 10
    s_lshl2_add_u32 s50, s35, s3
    s_lshl_b32 s50, s50, 15
    s_mul_i32 s41, s32, 224
    s_and_b32 s43, s56, 1
    s_xor_b32 s43, s43, 1
    s_mul_i32 s43, s43, 192
    s_add_u32 s66, s43, s41
    s_mul_i32 s41, s3, 114688
    s_add_u32 s69, s66, s41
    v_lshrrev_b32 v249, 1, v252
    v_mul_u32_u24 v249, 3584, v249
    v_and_b32 v248, 1, v252
    v_lshl_add_u32 v179, v248, 4, v249
    v_lshrrev_b32 v249, 3, v252
    v_bfe_u32 v247, v252, 2, 1
    v_xor_b32 v248, v244, v247
    v_lshl_add_u32 v248, v248, 2, v245
    v_mul_u32_u24 v249, 1024, v249
    v_lshl_add_u32 v184, v248, 4, v249
    v_add_u32 v185, 7168, v184
    v_add_u32 v186, 14336, v184
    v_add_u32 v187, 21504, v184
    s_and_b32 s42, s32, 7
    s_lshl1_add_u32 s43, s42, s58
    s_lshl4_add_u32 s41, s57, s43
    s_lshl_b32 s12, s41, 11
    s_add_u32 s12, s12, s48
    s_add_u32 s12, s12, 131072
    s_lshl_b32 s13, s41, 8
    s_add_u32 s13, s13, s48
    s_add_u32 s13, s13, 1114112
    s_lshl_b32 s41, s57, 7
    s_lshl2_add_u32 s14, s43, s41
    s_waitcnt vmcnt(1)
    v_cmp_ne_u32 vcc, s47, v135
    s_waitcnt vmcnt(0)
    v_cmp_ne_u32 s[60:61], s47, v139
    s_nop 0
    s_or_b64 vcc, vcc, s[60:61]
    s_cbranch_scc1 L_slow_20
L_back_22:
    v_lshlrev_b32 v124, 16, v132
    s_add_u32 m0, s70, 131072
    s_add_u32 s45, s67, 917504
    buffer_load_dwordx4 v182, s[20:23], s45 offen offset:2048 lds
    v_and_b32 v125, 0xffff0000, v132
    s_add_u32 m0, s70, 131072
    s_add_u32 s45, s67, 917504
    buffer_load_dwordx4 v183, s[20:23], s45 offen offset:3072 lds
    v_lshlrev_b32 v126, 16, v133
    v_and_b32 v128, 0xffff0000, v133
    v_lshlrev_b32 v192, 16, v136
    v_and_b32 v193, 0xffff0000, v136
    v_lshlrev_b32 v194, 16, v137
    v_and_b32 v195, 0xffff0000, v137
    v_add_f32 v129, v134, v138
    v_pk_add_f32 v[124:125], v[124:125], v[192:193]
    v_add_f32 v126, v126, v194
    v_add_f32 v128, v128, v195
    v_add_f32_dpp v124, v124, v124 row_ror:4 row_mask:0xf bank_mask:0xf
    v_add_f32_dpp v125, v125, v125 row_ror:4 row_mask:0xf bank_mask:0xf
    v_add_f32_dpp v126, v126, v126 row_ror:4 row_mask:0xf bank_mask:0xf
    v_add_f32_dpp v128, v128, v128 row_ror:4 row_mask:0xf bank_mask:0xf
    s_add_u32 m0, s70, 147456
    s_add_u32 s45, s67, 1376256
    buffer_load_dwordx4 v180, s[20:23], s45 offen lds
    v_add_f32_dpp v129, v129, v129 row_ror:4 row_mask:0xf bank_mask:0xf
    v_add_f32_dpp v124, v124, v124 row_ror:8 row_mask:0xf bank_mask:0xf
    v_add_f32_dpp v125, v125, v125 row_ror:8 row_mask:0xf bank_mask:0xf
    v_add_f32_dpp v126, v126, v126 row_ror:8 row_mask:0xf bank_mask:0xf
    v_add_f32_dpp v128, v128, v128 row_ror:8 row_mask:0xf bank_mask:0xf
    v_add_f32_dpp v129, v129, v129 row_ror:8 row_mask:0xf bank_mask:0xf
    v_mov_b32 v192, v124
    v_mov_b32 v193, v125
    v_mov_b32 v194, v126
    v_mov_b32 v195, v128
    v_mov_b32 v243, v129
    v_permlane16_swap_b32 v124, v192
    v_permlane16_swap_b32 v125, v193
    v_permlane16_swap_b32 v126, v194
    v_permlane16_swap_b32 v128, v195
    s_add_u32 m0, s70, 147456
    s_add_u32 s45, s67, 1376256
    buffer_load_dwordx4 v181, s[20:23], s45 offen offset:1024 lds
    v_permlane16_swap_b32 v129, v243
    v_add_f32 v124, v124, v192
    v_add_f32 v125, v125, v193
    v_add_f32 v126, v126, v194
    v_add_f32 v128, v128, v195
    v_add_f32 v129, v129, v243
    v_mov_b32 v192, v124
    v_mov_b32 v193, v125
    v_mov_b32 v194, v126
    v_mov_b32 v195, v128
    v_mov_b32 v243, v129
    v_permlane32_swap_b32 v124, v192
    v_permlane32_swap_b32 v125, v193
    v_permlane32_swap_b32 v126, v194
    v_permlane32_swap_b32 v128, v195
    s_add_u32 m0, s70, 147456
    s_add_u32 s45, s67, 1376256
    buffer_load_dwordx4 v182, s[20:23], s45 offen offset:2048 lds
    v_permlane32_swap_b32 v129, v243
    v_add_f32 v124, v124, v192
    v_add_f32 v125, v125, v193
    v_add_f32 v126, v126, v194
    v_add_f32 v128, v128, v195
    v_add_f32 v129, v129, v243
    v_cvt_pk_bf16_f32 v124, v124, v125
    v_cvt_pk_bf16_f32 v125, v126, v128
    v_cvt_pk_bf16_f32 v126, v129, v129
    s_mov_b64 exec, 0xff
    buffer_store_dwordx4 v[124:127], v240, s[28:31], s73 offen sc1
    s_mov_b64 exec, -1
    v_lshlrev_b32 v249, 1, v251
    v_and_b32 v248, 31, v249
    s_waitcnt lgkmcnt(0)
    buffer_load_ushort v232, v249, s[4:7], s64 offen
    buffer_load_ushort v233, v249, s[4:7], s64 offen offset:64
    buffer_load_ushort v234, v249, s[4:7], s65 offen
    buffer_load_ushort v235, v248, s[4:7], s66 offen
    v_add_f32 v200, v200, v201
    v_cvt_pk_bf16_f32 v242, v200, v200
    v_and_b32 v242, 0xffff0000, v242
    v_sub_f32 v242, v200, v242
    v_cvt_pk_bf16_f32 v212, v200, v242
    s_nop 1
    v_mfma_f32_32x32x16_bf16 v[28:43], v[212:215], v[208:211], v[28:43]
    s_add_u32 m0, s70, 147456
    s_add_u32 s45, s67, 1376256
    buffer_load_dwordx4 v183, s[20:23], s45 offen offset:3072 lds
    v_and_b32 v243, 15, v252
    v_lshrrev_b32 v242, 4, v252
    v_lshlrev_b32 v242, 3, v242
    v_lshl_add_u32 v243, v243, 5, v242
    s_mul_i32 s41, s3, 1088
    v_add_u32 v243, s41, v243
    v_lshl_add_u32 v242, v245, 1, v242
    v_add_u32 v242, s41, v242
    v_min_u32 v241, 16, v251
    v_mad_u32_u24 v241, v250, 17, v241
    s_mul_i32 s41, s58, 68
    s_add_u32 m0, s51, 0
    s_nop 0
    buffer_load_dwordx4 v184, s[16:19], s59 offen lds
    v_add_lshl_u32 v241, v241, s41, 5
    v_cvt_pk_bf16_f32 v4, v28, v29
    v_cvt_pk_bf16_f32 v5, v30, v31
    v_cvt_pk_bf16_f32 v6, v32, v33
    v_cvt_pk_bf16_f32 v7, v34, v35
    v_cvt_pk_bf16_f32 v8, v36, v37
    v_cvt_pk_bf16_f32 v9, v38, v39
    v_cvt_pk_bf16_f32 v10, v40, v41
    v_cvt_pk_bf16_f32 v11, v42, v43
    v_mfma_f32_32x32x16_bf16 v[28:43], v[116:119], v[4:7], 0
    s_add_u32 m0, s51, 0
    s_nop 0
    buffer_load_dwordx4 v185, s[16:19], s59 offen offset:1024 lds
    v_mfma_f32_32x32x16_bf16 v[84:99], v[120:123], v[8:11], 0
    s_and_b32 s42, s32, 7
    s_lshl1_add_u32 s42, s42, s58
    s_lshl4_add_u32 s41, s57, s42
    s_lshl_b32 s34, s41, 11
    s_add_u32 s34, s34, s48
    s_add_u32 m0, s51, 0
    s_nop 0
    buffer_load_dwordx4 v186, s[16:19], s59 offen offset:2048 lds
    s_lshl_b32 s41, s57, 7
    s_lshl2_add_u32 s15, s42, s41
    v_max3_f32 v44, v28, v29, v30
    v_max3_f32 v45, v31, v32, v33
    v_max3_f32 v48, v84, v85, v86
    v_max3_f32 v49, v87, v88, v89
    v_max3_f32 v44, v44, v34, v35
    v_max3_f32 v45, v45, v36, v37
    v_max3_f32 v48, v48, v90, v91
    v_max3_f32 v49, v49, v92, v93
    v_max3_f32 v44, v44, v38, v39
    v_max3_f32 v45, v45, v40, v41
    v_max3_f32 v48, v48, v94, v95
    v_max3_f32 v49, v49, v96, v97
    v_max3_f32 v44, v44, v42, v43
    s_add_u32 m0, s51, 0
    s_nop 0
    buffer_load_dwordx4 v187, s[16:19], s59 offen offset:3072 lds
    v_max3_f32 v48, v48, v98, v99
    v_max_f32 v44, v44, v45
    v_max_f32 v48, v48, v49
    v_mul_f32 v44, v44, v168
    v_mul_f32 v48, v48, v168
    v_pk_fma_f32 v[28:29], v[28:29], v[168:169], v[44:45] op_sel_hi:[1,0,0] neg_lo:[0,0,1] neg_hi:[0,0,1]
    v_pk_fma_f32 v[30:31], v[30:31], v[168:169], v[44:45] op_sel_hi:[1,0,0] neg_lo:[0,0,1] neg_hi:[0,0,1]
    v_pk_fma_f32 v[32:33], v[32:33], v[168:169], v[44:45] op_sel_hi:[1,0,0] neg_lo:[0,0,1] neg_hi:[0,0,1]
    v_pk_fma_f32 v[34:35], v[34:35], v[168:169], v[44:45] op_sel_hi:[1,0,0] neg_lo:[0,0,1] neg_hi:[0,0,1]
    v_pk_fma_f32 v[36:37], v[36:37], v[168:169], v[44:45] op_sel_hi:[1,0,0] neg_lo:[0,0,1] neg_hi:[0,0,1]
    v_pk_fma_f32 v[38:39], v[38:39], v[168:169], v[44:45] op_sel_hi:[1,0,0] neg_lo:[0,0,1] neg_hi:[0,0,1]
    v_pk_fma_f32 v[40:41], v[40:41], v[168:169], v[44:45] op_sel_hi:[1,0,0] neg_lo:[0,0,1] neg_hi:[0,0,1]
    v_pk_fma_f32 v[42:43], v[42:43], v[168:169], v[44:45] op_sel_hi:[1,0,0] neg_lo:[0,0,1] neg_hi:[0,0,1]
    v_pk_fma_f32 v[84:85], v[84:85], v[168:169], v[48:49] op_sel_hi:[1,0,0] neg_lo:[0,0,1] neg_hi:[0,0,1]
    v_pk_fma_f32 v[86:87], v[86:87], v[168:169], v[48:49] op_sel_hi:[1,0,0] neg_lo:[0,0,1] neg_hi:[0,0,1]
    s_add_u32 m0, s51, 4096
    s_add_u32 s45, s59, 32768
    buffer_load_dwordx4 v184, s[16:19], s45 offen lds
    v_pk_fma_f32 v[88:89], v[88:89], v[168:169], v[48:49] op_sel_hi:[1,0,0] neg_lo:[0,0,1] neg_hi:[0,0,1]
    v_pk_fma_f32 v[90:91], v[90:91], v[168:169], v[48:49] op_sel_hi:[1,0,0] neg_lo:[0,0,1] neg_hi:[0,0,1]
    v_pk_fma_f32 v[92:93], v[92:93], v[168:169], v[48:49] op_sel_hi:[1,0,0] neg_lo:[0,0,1] neg_hi:[0,0,1]
    v_pk_fma_f32 v[94:95], v[94:95], v[168:169], v[48:49] op_sel_hi:[1,0,0] neg_lo:[0,0,1] neg_hi:[0,0,1]
    v_pk_fma_f32 v[96:97], v[96:97], v[168:169], v[48:49] op_sel_hi:[1,0,0] neg_lo:[0,0,1] neg_hi:[0,0,1]
    v_pk_fma_f32 v[98:99], v[98:99], v[168:169], v[48:49] op_sel_hi:[1,0,0] neg_lo:[0,0,1] neg_hi:[0,0,1]
    v_exp_f32 v28, v28
    v_exp_f32 v29, v29
    v_exp_f32 v30, v30
    v_exp_f32 v31, v31
    v_exp_f32 v32, v32
    s_add_u32 m0, s51, 4096
    s_add_u32 s45, s59, 32768
    buffer_load_dwordx4 v185, s[16:19], s45 offen offset:1024 lds
    v_exp_f32 v33, v33
    v_exp_f32 v34, v34
    v_exp_f32 v35, v35
    v_exp_f32 v36, v36
    v_exp_f32 v37, v37
    v_exp_f32 v38, v38
    v_exp_f32 v39, v39
    s_add_u32 m0, s51, 4096
    s_add_u32 s45, s59, 32768
    buffer_load_dwordx4 v186, s[16:19], s45 offen offset:2048 lds
    v_exp_f32 v40, v40
    v_exp_f32 v41, v41
    v_exp_f32 v42, v42
    v_exp_f32 v43, v43
    v_exp_f32 v84, v84
    v_exp_f32 v85, v85
    v_exp_f32 v86, v86
    v_exp_f32 v87, v87
    s_add_u32 m0, s51, 4096
    s_add_u32 s45, s59, 32768
    buffer_load_dwordx4 v187, s[16:19], s45 offen offset:3072 lds
    v_exp_f32 v88, v88
    v_exp_f32 v89, v89
    v_exp_f32 v90, v90
    v_exp_f32 v91, v91
    v_exp_f32 v92, v92
    v_exp_f32 v93, v93
    v_exp_f32 v94, v94
    s_add_u32 m0, s51, 8192
    s_add_u32 s45, s59, 65536
    buffer_load_dwordx4 v184, s[16:19], s45 offen lds
    v_exp_f32 v95, v95
    v_exp_f32 v96, v96
    v_exp_f32 v97, v97
    v_exp_f32 v98, v98
    v_exp_f32 v99, v99
    v_pk_add_f32 v[44:45], v[28:29], v[30:31]
    v_pk_add_f32 v[46:47], v[32:33], v[34:35]
    v_pk_add_f32 v[48:49], v[84:85], v[86:87]
    v_pk_add_f32 v[50:51], v[88:89], v[90:91]
    v_pk_add_f32 v[44:45], v[44:45], v[36:37]
    s_add_u32 m0, s51, 8192
    s_add_u32 s45, s59, 65536
    buffer_load_dwordx4 v185, s[16:19], s45 offen offset:1024 lds
    v_pk_add_f32 v[46:47], v[46:47], v[38:39]
    v_pk_add_f32 v[48:49], v[48:49], v[92:93]
    v_pk_add_f32 v[50:51], v[50:51], v[94:95]
    v_pk_add_f32 v[44:45], v[44:45], v[40:41]
    v_pk_add_f32 v[46:47], v[46:47], v[42:43]
    v_pk_add_f32 v[48:49], v[48:49], v[96:97]
    v_pk_add_f32 v[50:51], v[50:51], v[98:99]
    v_pk_add_f32 v[44:45], v[44:45], v[46:47]
    v_pk_add_f32 v[48:49], v[48:49], v[50:51]
    v_add_f32 v44, v44, v45
    v_add_f32 v48, v48, v49
    v_rcp_f32 v44, v44
    v_rcp_f32 v48, v48
    s_add_u32 m0, s51, 8192
    s_add_u32 s45, s59, 65536
    buffer_load_dwordx4 v186, s[16:19], s45 offen offset:2048 lds
    v_pk_mul_f32 v[28:29], v[28:29], v[44:45] op_sel_hi:[1,0]
    v_pk_mul_f32 v[30:31], v[30:31], v[44:45] op_sel_hi:[1,0]
    v_pk_mul_f32 v[32:33], v[32:33], v[44:45] op_sel_hi:[1,0]
    v_pk_mul_f32 v[34:35], v[34:35], v[44:45] op_sel_hi:[1,0]
    v_pk_mul_f32 v[36:37], v[36:37], v[44:45] op_sel_hi:[1,0]
    v_pk_mul_f32 v[38:39], v[38:39], v[44:45] op_sel_hi:[1,0]
    v_pk_mul_f32 v[40:41], v[40:41], v[44:45] op_sel_hi:[1,0]
    v_pk_mul_f32 v[42:43], v[42:43], v[44:45] op_sel_hi:[1,0]
    v_cvt_pk_bf16_f32 v100, v28, v29
    v_cvt_pk_bf16_f32 v101, v30, v31
    v_cvt_pk_bf16_f32 v102, v32, v33
    v_cvt_pk_bf16_f32 v103, v34, v35
    v_cvt_pk_bf16_f32 v104, v36, v37
    v_cvt_pk_bf16_f32 v105, v38, v39
    v_cvt_pk_bf16_f32 v106, v40, v41
    s_add_u32 m0, s51, 8192
    s_add_u32 s45, s59, 65536
    buffer_load_dwordx4 v187, s[16:19], s45 offen offset:3072 lds
    v_cvt_pk_bf16_f32 v107, v42, v43
    v_pk_mul_f32 v[84:85], v[84:85], v[48:49] op_sel_hi:[1,0]
    v_pk_mul_f32 v[86:87], v[86:87], v[48:49] op_sel_hi:[1,0]
    v_pk_mul_f32 v[88:89], v[88:89], v[48:49] op_sel_hi:[1,0]
    v_pk_mul_f32 v[90:91], v[90:91], v[48:49] op_sel_hi:[1,0]
    v_pk_mul_f32 v[92:93], v[92:93], v[48:49] op_sel_hi:[1,0]
    v_pk_mul_f32 v[94:95], v[94:95], v[48:49] op_sel_hi:[1,0]
    v_pk_mul_f32 v[96:97], v[96:97], v[48:49] op_sel_hi:[1,0]
    v_pk_mul_f32 v[98:99], v[98:99], v[48:49] op_sel_hi:[1,0]
    v_cvt_pk_bf16_f32 v108, v84, v85
    buffer_load_dwordx4 v[132:135], v173, s[28:31], s74 offen sc1
    buffer_load_dwordx4 v[136:139], v173, s[28:31], s74 offen offset:2048 sc1
    v_cvt_pk_bf16_f32 v109, v86, v87
    v_cvt_pk_bf16_f32 v110, v88, v89
    v_cvt_pk_bf16_f32 v111, v90, v91
    v_cvt_pk_bf16_f32 v112, v92, v93
    v_cvt_pk_bf16_f32 v113, v94, v95
    s_add_u32 m0, s51, 12288
    s_add_u32 s45, s59, 98304
    buffer_load_dwordx4 v184, s[16:19], s45 offen lds
    v_cvt_pk_bf16_f32 v114, v96, v97
    v_cvt_pk_bf16_f32 v115, v98, v99
    s_waitcnt vmcnt(2)
    v_cmp_ne_u32 vcc, s47, v135
    s_waitcnt vmcnt(1)
    v_cmp_ne_u32 s[60:61], s47, v139
    s_nop 0
    s_or_b64 vcc, vcc, s[60:61]
    s_cbranch_scc1 L_slow_23
L_back_25:
    ds_write_b64 v243, v[132:133] offset:26624
    ds_write_b16 v242, v134 offset:27136
    ds_write_b64 v243, v[136:137] offset:27168
    ds_write_b16 v242, v138 offset:27680
    s_waitcnt lgkmcnt(0)
    s_barrier
    ds_read_b128 v[52:55], v241 offset:26624
    ds_read_b128 v[56:59], v241 offset:26640
    ds_read_b128 v[60:63], v241 offset:27712
    ds_read_b128 v[64:67], v241 offset:27728
    s_waitcnt lgkmcnt(3)
    v_mfma_f32_32x32x16_bf16 v[28:43], v[52:55], v[100:103], 0
    s_waitcnt lgkmcnt(2)
    v_mfma_f32_32x32x16_bf16 v[28:43], v[56:59], v[104:107], v[28:43]
    s_waitcnt lgkmcnt(1)
    v_mfma_f32_32x32x16_bf16 v[84:99], v[60:63], v[108:111], 0
    s_waitcnt lgkmcnt(0)
    v_mfma_f32_32x32x16_bf16 v[84:99], v[64:67], v[112:115], v[84:99]
    s_nop 7
    v_add_f32 v36, 0x358637bd, v36
    v_rcp_f32 v36, v36
    s_nop 0
    v_pk_mul_f32 v[28:29], v[28:29], v[36:37] op_sel_hi:[1,0]
    v_pk_mul_f32 v[30:31], v[30:31], v[36:37] op_sel_hi:[1,0]
    v_pk_mul_f32 v[32:33], v[32:33], v[36:37] op_sel_hi:[1,0]
    v_pk_mul_f32 v[34:35], v[34:35], v[36:37] op_sel_hi:[1,0]
    v_cvt_pk_bf16_f32 v4, v28, v29
    v_cvt_pk_bf16_f32 v5, v30, v31
    v_cvt_pk_bf16_f32 v6, v32, v33
    v_cvt_pk_bf16_f32 v7, v34, v35
    buffer_store_dwordx4 v[4:7], v240, s[28:31], s34 offen offset:0 sc1
    v_add_f32 v92, 0x358637bd, v92
    v_rcp_f32 v92, v92
    s_nop 0
    v_pk_mul_f32 v[84:85], v[84:85], v[92:93] op_sel_hi:[1,0]
    v_pk_mul_f32 v[86:87], v[86:87], v[92:93] op_sel_hi:[1,0]
    v_pk_mul_f32 v[88:89], v[88:89], v[92:93] op_sel_hi:[1,0]
    v_pk_mul_f32 v[90:91], v[90:91], v[92:93] op_sel_hi:[1,0]
    v_cvt_pk_bf16_f32 v8, v84, v85
    v_cvt_pk_bf16_f32 v9, v86, v87
    v_cvt_pk_bf16_f32 v10, v88, v89
    v_cvt_pk_bf16_f32 v11, v90, v91
    buffer_store_dwordx4 v[8:11], v240, s[28:31], s34 offen offset:1024 sc1
    s_add_u32 m0, s51, 12288
    s_add_u32 s45, s59, 98304
    buffer_load_dwordx4 v185, s[16:19], s45 offen offset:1024 lds
    s_add_u32 m0, s51, 12288
    s_add_u32 s45, s59, 98304
    buffer_load_dwordx4 v186, s[16:19], s45 offen offset:2048 lds
    s_add_u32 m0, s51, 12288
    s_add_u32 s45, s59, 98304
    buffer_load_dwordx4 v187, s[16:19], s45 offen offset:3072 lds
    v_lshl_add_u32 v237, v250, 2, v239
    v_lshlrev_b32 v237, 7, v237
    v_lshrrev_b32 v236, 1, v239
    v_xor_b32 v236, 0, v236
    v_lshl_add_u32 v236, v236, 1, v244
    v_lshl_add_u32 v236, v236, 2, v245
    v_lshl_add_u32 v228, v236, 3, v237
    v_add_u32 v228, 98304, v228
    v_xor_b32 v229, 64, v228
    v_lshl_add_u32 v242, v250, 2, v239
    v_lshl_add_u32 v241, v244, 2, v245
    v_lshlrev_b32 v238, 6, v242
    v_lshl_add_u32 v230, v241, 3, v238
    v_add_u32 v230, 98304, v230
    v_lshlrev_b32 v238, 5, v242
    v_lshl_add_u32 v231, v245, 3, v238
    v_add_u32 v224, s70, v228
    v_add_u32 v225, s70, v229
    v_add_u32 v226, s53, v230
    v_add_u32 v227, s52, v231
    ds_read_b64_tr_b16 a[128:129], v230 offset:0
    ds_read_b64_tr_b16 a[130:131], v230 offset:512
    ds_read_b64_tr_b16 a[132:133], v230 offset:1024
    ds_read_b64_tr_b16 a[134:135], v230 offset:1536
    ds_read_b64_tr_b16 a[136:137], v230 offset:2048
    ds_read_b64_tr_b16 a[138:139], v230 offset:2560
    ds_read_b64_tr_b16 a[140:141], v230 offset:3072
    ds_read_b64_tr_b16 a[142:143], v230 offset:3584
    ds_read_b64_tr_b16 a[144:145], v230 offset:4096
    ds_read_b64_tr_b16 a[146:147], v230 offset:4608
    ds_read_b64_tr_b16 a[148:149], v230 offset:5120
    ds_read_b64_tr_b16 a[150:151], v230 offset:5632
    ds_read_b64_tr_b16 a[152:153], v230 offset:6144
    ds_read_b64_tr_b16 a[154:155], v230 offset:6656
    ds_read_b64_tr_b16 a[156:157], v230 offset:7168
    ds_read_b64_tr_b16 a[158:159], v230 offset:7680
    ds_read_b64_tr_b16 a[160:161], v230 offset:8192
    ds_read_b64_tr_b16 a[162:163], v230 offset:8704
    ds_read_b64_tr_b16 a[164:165], v230 offset:9216
    ds_read_b64_tr_b16 a[166:167], v230 offset:9728
    ds_read_b64_tr_b16 a[168:169], v230 offset:10240
    ds_read_b64_tr_b16 a[170:171], v230 offset:10752
    ds_read_b64_tr_b16 a[172:173], v230 offset:11264
    ds_read_b64_tr_b16 a[174:175], v230 offset:11776
    ds_read_b64_tr_b16 a[176:177], v230 offset:12288
    ds_read_b64_tr_b16 a[178:179], v230 offset:12800
    ds_read_b64_tr_b16 a[180:181], v230 offset:13312
    ds_read_b64_tr_b16 a[182:183], v230 offset:13824
    ds_read_b64_tr_b16 a[184:185], v230 offset:14336
    ds_read_b64_tr_b16 a[186:187], v230 offset:14848
    ds_read_b64_tr_b16 a[188:189], v230 offset:15360
    ds_read_b64_tr_b16 a[190:191], v230 offset:15872
    ds_read_b64_tr_b16 a[192:193], v230 offset:16384
    ds_read_b64_tr_b16 a[194:195], v230 offset:16896
    ds_read_b64_tr_b16 a[196:197], v230 offset:17408
    ds_read_b64_tr_b16 a[198:199], v230 offset:17920
    ds_read_b64_tr_b16 a[200:201], v230 offset:18432
    ds_read_b64_tr_b16 a[202:203], v230 offset:18944
    ds_read_b64_tr_b16 a[204:205], v230 offset:19456
    ds_read_b64_tr_b16 a[206:207], v230 offset:19968
    ds_read_b64_tr_b16 a[208:209], v230 offset:20480
    ds_read_b64_tr_b16 a[210:211], v230 offset:20992
    ds_read_b64_tr_b16 a[212:213], v230 offset:21504
    ds_read_b64_tr_b16 a[214:215], v230 offset:22016
    ds_read_b64_tr_b16 a[216:217], v230 offset:22528
    ds_read_b64_tr_b16 a[218:219], v230 offset:23040
    ds_read_b64_tr_b16 a[220:221], v230 offset:23552
    ds_read_b64_tr_b16 a[222:223], v230 offset:24064
    ds_read_b64_tr_b16 a[224:225], v230 offset:24576
    ds_read_b64_tr_b16 a[226:227], v230 offset:25088
    ds_read_b64_tr_b16 a[228:229], v230 offset:25600
    ds_read_b64_tr_b16 a[230:231], v230 offset:26112
    ds_read_b64_tr_b16 a[232:233], v230 offset:26624
    ds_read_b64_tr_b16 a[234:235], v230 offset:27136
    ds_read_b64_tr_b16 a[236:237], v230 offset:27648
    ds_read_b64_tr_b16 a[238:239], v230 offset:28160
    s_waitcnt vmcnt(3)
    s_add_u32 s45, s15, s49
    s_mov_b64 exec, 1
    s_cmp_eq_u32 s33, 0
    s_cbranch_scc1 L_wt_26
    buffer_store_dword v190, v191, s[28:31], s45 offen offset:0
L_wb_27:
    s_mov_b64 exec, -1
    ds_read_b64_tr_b16 a[240:241], v230 offset:28672
    ds_read_b64_tr_b16 a[242:243], v230 offset:29184
    ds_read_b64_tr_b16 a[244:245], v230 offset:29696
    ds_read_b64_tr_b16 a[246:247], v230 offset:30208
    ds_read_b64_tr_b16 a[248:249], v230 offset:30720
    ds_read_b64_tr_b16 a[250:251], v230 offset:31232
    ds_read_b64_tr_b16 a[252:253], v230 offset:31744
    ds_read_b64_tr_b16 a[254:255], v230 offset:32256
    ds_read_b64_tr_b16 v[52:53], v226 offset:0
    ds_read_b64_tr_b16 v[54:55], v226 offset:512
    ds_read_b64_tr_b16 v[56:57], v226 offset:8192
    ds_read_b64_tr_b16 v[58:59], v226 offset:8704
    ds_read_b64_tr_b16 v[60:61], v226 offset:16384
    ds_read_b64_tr_b16 v[62:63], v226 offset:16896
    ds_read_b64_tr_b16 v[64:65], v226 offset:24576
    ds_read_b64_tr_b16 v[66:67], v226 offset:25088
    ds_read_b64_tr_b16 v[68:69], v226 offset:1024
    ds_read_b64_tr_b16 v[70:71], v226 offset:1536
    ds_read_b64_tr_b16 v[72:73], v226 offset:9216
    ds_read_b64_tr_b16 v[74:75], v226 offset:9728
    ds_read_b64_tr_b16 v[76:77], v226 offset:17408
    ds_read_b64_tr_b16 v[78:79], v226 offset:17920
    ds_read_b64_tr_b16 v[80:81], v226 offset:25600
    ds_read_b64_tr_b16 v[82:83], v226 offset:26112
    s_waitcnt lgkmcnt(14)
    v_mfma_f32_16x16x32_bf16 v[204:207], v[220:223], v[52:55], 0
    s_waitcnt lgkmcnt(12)
    v_mfma_f32_16x16x32_bf16 v[204:207], v[220:223], v[56:59], v[204:207]
    s_waitcnt lgkmcnt(10)
    v_mfma_f32_16x16x32_bf16 v[204:207], v[220:223], v[60:63], v[204:207]
    s_waitcnt lgkmcnt(8)
    v_mfma_f32_16x16x32_bf16 v[204:207], v[220:223], v[64:67], v[204:207]
    s_waitcnt lgkmcnt(6)
    v_mfma_f32_16x16x32_bf16 v[204:207], v[220:223], v[68:71], v[204:207]
    s_waitcnt lgkmcnt(4)
    v_mfma_f32_16x16x32_bf16 v[204:207], v[220:223], v[72:75], v[204:207]
    s_waitcnt lgkmcnt(2)
    v_mfma_f32_16x16x32_bf16 v[204:207], v[220:223], v[76:79], v[204:207]
    s_waitcnt lgkmcnt(0)
    v_mfma_f32_16x16x32_bf16 v[204:207], v[220:223], v[80:83], v[204:207]
    v_and_b32 v249, 7, v252
    s_lshl_b32 s41, s57, 5
    s_lshl3_add_u32 s41, s58, s41
    v_add_lshl_u32 v249, v249, s41, 2
    s_lshl1_add_u32 s41, s57, s58
    s_lshl_b32 s34, s41, 14
    s_add_u32 s34, s34, s48
    buffer_load_dword v189, v249, s[28:31], s49 offen offset:0 sc1
    s_add_u32 m0, s52, 0
    s_nop 0
    buffer_load_dwordx4 v179, s[20:23], s69 offen lds
    s_add_u32 m0, s52, 4096
    s_add_u32 s45, s69, 458752
    buffer_load_dwordx4 v179, s[20:23], s45 offen lds
    s_add_u32 m0, s52, 8192
    s_add_u32 s45, s69, 917504
    buffer_load_dwordx4 v179, s[20:23], s45 offen lds
    s_add_u32 m0, s52, 12288
    s_add_u32 s45, s69, 1376256
    buffer_load_dwordx4 v179, s[20:23], s45 offen lds
    v_and_b32 v242, 1, v251
    v_lshlrev_b32 v242, 4, v242
    v_mov_b32 v238, 0x3f80
    v_lshlrev_b32 v238, v242, v238
    v_lshrrev_b32 v242, 1, v251
    v_lshlrev_b32 v241, 2, v250
    v_sub_u32 v241, v242, v241
    v_cmp_eq_u32 s[60:61], 0, v241
    v_cmp_eq_u32 vcc, 1, v241
    s_nop 0
    v_cndmask_b32 v4, 0, v238, s[60:61]
    v_cndmask_b32 v5, 0, v238, vcc
    v_cmp_eq_u32 s[60:61], 2, v241
    v_cmp_eq_u32 vcc, 3, v241
    s_nop 0
    v_cndmask_b32 v6, 0, v238, s[60:61]
    v_cndmask_b32 v7, 0, v238, vcc
    v_cmp_eq_u32 s[60:61], 8, v241
    v_cmp_eq_u32 vcc, 9, v241
    s_nop 0
    v_cndmask_b32 v8, 0, v238, s[60:61]
    v_cndmask_b32 v9, 0, v238, vcc
    v_cmp_eq_u32 s[60:61], 10, v241
    v_cmp_eq_u32 vcc, 11, v241
    s_nop 0
    v_cndmask_b32 v10, 0, v238, s[60:61]
    v_cndmask_b32 v11, 0, v238, vcc
    s_waitcnt vmcnt(6)
    s_waitcnt lgkmcnt(0)
    s_barrier
    s_waitcnt vmcnt(4)
    v_cmp_ne_u32 vcc, s47, v189
    s_cbranch_vccnz L_slow_28
L_back_30:
    buffer_load_dwordx4 a[0:3], v240, s[28:31], s34 offen offset:0 sc1
    buffer_load_dwordx4 a[4:7], v240, s[28:31], s34 offen offset:1024 sc1
    buffer_load_dwordx4 a[8:11], v240, s[28:31], s34 offen offset:2048 sc1
    buffer_load_dwordx4 a[12:15], v240, s[28:31], s34 offen offset:3072 sc1
    s_add_u32 s34, s34, 4096
    buffer_load_dwordx4 a[16:19], v240, s[28:31], s34 offen offset:0 sc1
    buffer_load_dwordx4 a[20:23], v240, s[28:31], s34 offen offset:1024 sc1
    buffer_load_dwordx4 a[24:27], v240, s[28:31], s34 offen offset:2048 sc1
    buffer_load_dwordx4 a[28:31], v240, s[28:31], s34 offen offset:3072 sc1
    s_lshl_b32 s41, s58, 15
    s_add_u32 s41, s41, 32768
    v_lshl_add_u32 v242, v250, 2, v239
    v_lshlrev_b32 v242, 7, v242
    v_lshrrev_b32 v241, 1, v239
    v_xor_b32 v241, s58, v241
    v_lshl_add_u32 v241, v241, 1, v244
    v_lshl_add_u32 v241, v241, 2, v245
    v_lshl_add_u32 v246, v241, 3, v242
    v_add_u32 v246, s41, v246
    v_xor_b32 v243, 64, v246
    v_mfma_f32_32x32x16_bf16 v[20:35], v[4:7], v[12:15], 0
    v_mfma_f32_32x32x16_bf16 v[20:35], v[8:11], v[16:19], v[20:35]
    v_add_u32 v248, s70, v240
    v_xor_b32 v247, 0x2000, v248
    v_lshrrev_b32 v241, 4, v252
    v_xor_b32 v238, v241, v239
    v_add_u32 v238, s55, v238
    v_and_b32 v238, 3, v238
    v_lshl_add_u32 v238, v238, 2, v245
    v_lshlrev_b32 v241, 10, v241
    v_lshl_add_u32 v242, v238, 4, v241
    s_lshl_b32 s41, s56, 8
    v_add_u32 v242, s41, v242
    s_mul_i32 s44, s55, 448
    s_lshl2_add_u32 s44, s3, s44
    s_add_u32 s41, s56, 0
    s_and_b32 s41, s41, 3
    s_lshl2_add_u32 s42, s55, s41
    s_lshl4_add_u32 s42, s3, s42
    s_mul_i32 s42, s42, 7168
    s_add_u32 s42, s42, s48
    s_add_u32 s72, s42, 262144
    s_mul_i32 s42, s41, 112
    s_add_u32 s42, s42, s44
    s_lshl4_add_u32 s43, s41, s42
    s_lshl_b32 s16, s43, 10
    s_xor_b32 s43, s41, 2
    s_lshr_b32 s43, s43, 1
    s_and_b32 s41, s41, 1
    s_lshl2_add_u32 s43, s43, s41
    s_lshl4_add_u32 s43, s43, s42
    s_lshl_b32 s17, s43, 10
    s_xor_b32 s41, s41, 1
    s_mul_i32 s41, s41, 96
    s_add_u32 s41, s41, s42
    s_lshl_b32 s18, s41, 10
    s_add_u32 s41, s56, 1
    s_and_b32 s41, s41, 3
    s_lshl2_add_u32 s42, s55, s41
    s_lshl4_add_u32 s42, s3, s42
    s_mul_i32 s42, s42, 7168
    s_add_u32 s42, s42, s48
    s_add_u32 s73, s42, 262144
    s_mul_i32 s42, s41, 112
    s_add_u32 s42, s42, s44
    s_lshl4_add_u32 s43, s41, s42
    s_lshl_b32 s19, s43, 10
    s_xor_b32 s43, s41, 2
    s_lshr_b32 s43, s43, 1
    s_and_b32 s41, s41, 1
    s_lshl2_add_u32 s43, s43, s41
    s_lshl4_add_u32 s43, s43, s42
    s_lshl_b32 s36, s43, 10
    s_xor_b32 s41, s41, 1
    s_mul_i32 s41, s41, 96
    s_add_u32 s41, s41, s42
    s_lshl_b32 s37, s41, 10
    s_add_u32 s41, s56, 2
    s_and_b32 s41, s41, 3
    s_lshl2_add_u32 s42, s55, s41
    s_lshl4_add_u32 s42, s3, s42
    s_mul_i32 s42, s42, 7168
    s_add_u32 s42, s42, s48
    s_add_u32 s74, s42, 262144
    s_mul_i32 s42, s41, 112
    s_add_u32 s42, s42, s44
    s_lshl4_add_u32 s43, s41, s42
    s_lshl_b32 s38, s43, 10
    s_xor_b32 s43, s41, 2
    s_lshr_b32 s43, s43, 1
    s_and_b32 s41, s41, 1
    s_lshl2_add_u32 s43, s43, s41
    s_lshl4_add_u32 s43, s43, s42
    s_lshl_b32 s39, s43, 10
    s_xor_b32 s41, s41, 1
    s_mul_i32 s41, s41, 96
    s_add_u32 s41, s41, s42
    s_lshl_b32 s40, s41, 10
    s_add_u32 s41, s56, 3
    s_and_b32 s41, s41, 3
    s_lshl2_add_u32 s42, s55, s41
    s_lshl4_add_u32 s42, s3, s42
    s_mul_i32 s42, s42, 7168
    s_add_u32 s42, s42, s48
    s_add_u32 s75, s42, 262144
    s_mul_i32 s42, s41, 112
    s_add_u32 s42, s42, s44
    s_lshl4_add_u32 s43, s41, s42
    s_lshl_b32 s54, s43, 10
    s_xor_b32 s43, s41, 2
    s_lshr_b32 s43, s43, 1
    s_and_b32 s41, s41, 1
    s_lshl2_add_u32 s43, s43, s41
    s_lshl4_add_u32 s43, s43, s42
    s_lshl_b32 s59, s43, 10
    s_xor_b32 s41, s41, 1
    s_mul_i32 s41, s41, 96
    s_add_u32 s41, s41, s42
    s_lshl_b32 s71, s41, 10
    ds_read_b64_tr_b16 v[52:53], v243 offset:0
    ds_read_b64_tr_b16 v[54:55], v243 offset:1024
    ds_read_b64_tr_b16 v[56:57], v246 offset:0
    ds_read_b64_tr_b16 v[58:59], v246 offset:1024
    ds_read_b64_tr_b16 v[60:61], v243 offset:2048
    ds_read_b64_tr_b16 v[62:63], v243 offset:3072
    ds_read_b64_tr_b16 v[64:65], v246 offset:2048
    ds_read_b64_tr_b16 v[66:67], v246 offset:3072
    ds_read_b64_tr_b16 v[68:69], v243 offset:4096
    ds_read_b64_tr_b16 v[70:71], v243 offset:5120
    ds_read_b64_tr_b16 v[72:73], v246 offset:4096
    ds_read_b64_tr_b16 v[74:75], v246 offset:5120
    ds_read_b64_tr_b16 v[76:77], v243 offset:6144
    ds_read_b64_tr_b16 v[78:79], v243 offset:7168
    s_waitcnt vmcnt(7) lgkmcnt(12)
    v_mfma_f32_32x32x16_bf16 v[36:51], v[52:55], a[0:3], 0
    s_add_u32 s34, s34, 4096
    buffer_load_dwordx4 a[32:35], v240, s[28:31], s34 offen offset:0 sc1
    ds_read_b64_tr_b16 v[80:81], v246 offset:6144
    ds_read_b64_tr_b16 v[82:83], v246 offset:7168
    s_waitcnt lgkmcnt(12)
    v_mfma_f32_32x32x16_bf16 v[20:35], v[56:59], a[0:3], v[20:35]
    ds_read_b64_tr_b16 v[52:53], v243 offset:8192
    ds_read_b64_tr_b16 v[54:55], v243 offset:9216
    s_waitcnt vmcnt(7) lgkmcnt(12)
    v_mfma_f32_32x32x16_bf16 v[36:51], v[60:63], a[4:7], v[36:51]
    buffer_load_dwordx4 a[36:39], v240, s[28:31], s34 offen offset:1024 sc1
    ds_read_b64_tr_b16 v[56:57], v246 offset:8192
    ds_read_b64_tr_b16 v[58:59], v246 offset:9216
    s_waitcnt lgkmcnt(12)
    v_mfma_f32_32x32x16_bf16 v[20:35], v[64:67], a[4:7], v[20:35]
    ds_read_b64_tr_b16 v[60:61], v243 offset:10240
    ds_read_b64_tr_b16 v[62:63], v243 offset:11264
    s_waitcnt vmcnt(7) lgkmcnt(12)
    v_mfma_f32_32x32x16_bf16 v[36:51], v[68:71], a[8:11], v[36:51]
    buffer_load_dwordx4 a[40:43], v240, s[28:31], s34 offen offset:2048 sc1
    ds_read_b64_tr_b16 v[64:65], v246 offset:10240
    ds_read_b64_tr_b16 v[66:67], v246 offset:11264
    s_waitcnt lgkmcnt(12)
    v_mfma_f32_32x32x16_bf16 v[20:35], v[72:75], a[8:11], v[20:35]
    ds_read_b64_tr_b16 v[68:69], v243 offset:12288
    ds_read_b64_tr_b16 v[70:71], v243 offset:13312
    s_waitcnt vmcnt(7) lgkmcnt(12)
    v_mfma_f32_32x32x16_bf16 v[36:51], v[76:79], a[12:15], v[36:51]
    buffer_load_dwordx4 a[44:47], v240, s[28:31], s34 offen offset:3072 sc1
    ds_read_b64_tr_b16 v[72:73], v246 offset:12288
    ds_read_b64_tr_b16 v[74:75], v246 offset:13312
    s_waitcnt lgkmcnt(12)
    v_mfma_f32_32x32x16_bf16 v[20:35], v[80:83], a[12:15], v[20:35]
    ds_read_b64_tr_b16 v[76:77], v243 offset:14336
    ds_read_b64_tr_b16 v[78:79], v243 offset:15360
    s_waitcnt vmcnt(7) lgkmcnt(12)
    v_mfma_f32_32x32x16_bf16 v[36:51], v[52:55], a[16:19], v[36:51]
    s_add_u32 s34, s34, 4096
    buffer_load_dwordx4 a[48:51], v240, s[28:31], s34 offen offset:0 sc1
    ds_read_b64_tr_b16 v[80:81], v246 offset:14336
    ds_read_b64_tr_b16 v[82:83], v246 offset:15360
    s_waitcnt lgkmcnt(12)
    v_mfma_f32_32x32x16_bf16 v[20:35], v[56:59], a[16:19], v[20:35]
    ds_read_b64_tr_b16 v[52:53], v243 offset:16384
    ds_read_b64_tr_b16 v[54:55], v243 offset:17408
    s_waitcnt vmcnt(7) lgkmcnt(12)
    v_mfma_f32_32x32x16_bf16 v[36:51], v[60:63], a[20:23], v[36:51]
    buffer_load_dwordx4 a[52:55], v240, s[28:31], s34 offen offset:1024 sc1
    ds_read_b64_tr_b16 v[56:57], v246 offset:16384
    ds_read_b64_tr_b16 v[58:59], v246 offset:17408
    s_waitcnt lgkmcnt(12)
    v_mfma_f32_32x32x16_bf16 v[20:35], v[64:67], a[20:23], v[20:35]
    ds_read_b64_tr_b16 v[60:61], v243 offset:18432
    ds_read_b64_tr_b16 v[62:63], v243 offset:19456
    s_waitcnt vmcnt(7) lgkmcnt(12)
    v_mfma_f32_32x32x16_bf16 v[36:51], v[68:71], a[24:27], v[36:51]
    buffer_load_dwordx4 a[56:59], v240, s[28:31], s34 offen offset:2048 sc1
    ds_read_b64_tr_b16 v[64:65], v246 offset:18432
    ds_read_b64_tr_b16 v[66:67], v246 offset:19456
    s_waitcnt lgkmcnt(12)
    v_mfma_f32_32x32x16_bf16 v[20:35], v[72:75], a[24:27], v[20:35]
    ds_read_b64_tr_b16 v[68:69], v243 offset:20480
    ds_read_b64_tr_b16 v[70:71], v243 offset:21504
    s_waitcnt vmcnt(7) lgkmcnt(12)
    v_mfma_f32_32x32x16_bf16 v[36:51], v[76:79], a[28:31], v[36:51]
    buffer_load_dwordx4 a[60:63], v240, s[28:31], s34 offen offset:3072 sc1
    ds_read_b64_tr_b16 v[72:73], v246 offset:20480
    ds_read_b64_tr_b16 v[74:75], v246 offset:21504
    s_waitcnt lgkmcnt(12)
    v_mfma_f32_32x32x16_bf16 v[20:35], v[80:83], a[28:31], v[20:35]
    s_add_u32 m0, s70, 98304
    s_nop 0
    buffer_load_dwordx4 v180, s[20:23], s67 offen lds
    ds_read_b64_tr_b16 v[76:77], v243 offset:22528
    ds_read_b64_tr_b16 v[78:79], v243 offset:23552
    s_waitcnt vmcnt(8) lgkmcnt(12)
    v_mfma_f32_32x32x16_bf16 v[36:51], v[52:55], a[32:35], v[36:51]
    ds_read_b64_tr_b16 v[80:81], v246 offset:22528
    ds_read_b64_tr_b16 v[82:83], v246 offset:23552
    s_waitcnt lgkmcnt(12)
    v_mfma_f32_32x32x16_bf16 v[20:35], v[56:59], a[32:35], v[20:35]
    s_add_u32 m0, s70, 98304
    s_nop 0
    buffer_load_dwordx4 v181, s[20:23], s67 offen offset:1024 lds
    ds_read_b64_tr_b16 v[52:53], v243 offset:24576
    ds_read_b64_tr_b16 v[54:55], v243 offset:25600
    s_waitcnt vmcnt(8) lgkmcnt(12)
    v_mfma_f32_32x32x16_bf16 v[36:51], v[60:63], a[36:39], v[36:51]
    ds_read_b64_tr_b16 v[56:57], v246 offset:24576
    ds_read_b64_tr_b16 v[58:59], v246 offset:25600
    s_waitcnt lgkmcnt(12)
    v_mfma_f32_32x32x16_bf16 v[20:35], v[64:67], a[36:39], v[20:35]
    s_add_u32 m0, s70, 98304
    s_nop 0
    buffer_load_dwordx4 v182, s[20:23], s67 offen offset:2048 lds
    ds_read_b64_tr_b16 v[60:61], v243 offset:26624
    ds_read_b64_tr_b16 v[62:63], v243 offset:27648
    s_waitcnt vmcnt(8) lgkmcnt(12)
    v_mfma_f32_32x32x16_bf16 v[36:51], v[68:71], a[40:43], v[36:51]
    ds_read_b64_tr_b16 v[64:65], v246 offset:26624
    ds_read_b64_tr_b16 v[66:67], v246 offset:27648
    s_waitcnt lgkmcnt(12)
    v_mfma_f32_32x32x16_bf16 v[20:35], v[72:75], a[40:43], v[20:35]
    s_add_u32 m0, s70, 98304
    s_nop 0
    buffer_load_dwordx4 v183, s[20:23], s67 offen offset:3072 lds
    ds_read_b64_tr_b16 v[68:69], v243 offset:28672
    ds_read_b64_tr_b16 v[70:71], v243 offset:29696
    s_waitcnt vmcnt(8) lgkmcnt(12)
    v_mfma_f32_32x32x16_bf16 v[36:51], v[76:79], a[44:47], v[36:51]
    ds_read_b64_tr_b16 v[72:73], v246 offset:28672
    ds_read_b64_tr_b16 v[74:75], v246 offset:29696
    s_waitcnt lgkmcnt(12)
    v_mfma_f32_32x32x16_bf16 v[20:35], v[80:83], a[44:47], v[20:35]
    s_add_u32 m0, s70, 114688
    s_add_u32 s45, s67, 458752
    buffer_load_dwordx4 v180, s[20:23], s45 offen lds
    ds_read_b64_tr_b16 v[76:77], v243 offset:30720
    ds_read_b64_tr_b16 v[78:79], v243 offset:31744
    s_waitcnt vmcnt(8) lgkmcnt(12)
    v_mfma_f32_32x32x16_bf16 v[36:51], v[52:55], a[48:51], v[36:51]
    ds_read_b64_tr_b16 v[80:81], v246 offset:30720
    ds_read_b64_tr_b16 v[82:83], v246 offset:31744
    s_waitcnt lgkmcnt(12)
    v_mfma_f32_32x32x16_bf16 v[20:35], v[56:59], a[48:51], v[20:35]
    s_add_u32 m0, s70, 114688
    s_add_u32 s45, s67, 458752
    buffer_load_dwordx4 v181, s[20:23], s45 offen offset:1024 lds
    s_waitcnt vmcnt(8) lgkmcnt(10)
    v_mfma_f32_32x32x16_bf16 v[36:51], v[60:63], a[52:55], v[36:51]
    s_waitcnt lgkmcnt(8)
    v_mfma_f32_32x32x16_bf16 v[20:35], v[64:67], a[52:55], v[20:35]
    s_add_u32 m0, s70, 114688
    s_add_u32 s45, s67, 458752
    buffer_load_dwordx4 v182, s[20:23], s45 offen offset:2048 lds
    s_waitcnt vmcnt(8) lgkmcnt(6)
    v_mfma_f32_32x32x16_bf16 v[36:51], v[68:71], a[56:59], v[36:51]
    s_waitcnt lgkmcnt(4)
    v_mfma_f32_32x32x16_bf16 v[20:35], v[72:75], a[56:59], v[20:35]
    s_add_u32 m0, s70, 114688
    s_add_u32 s45, s67, 458752
    buffer_load_dwordx4 v183, s[20:23], s45 offen offset:3072 lds
    s_waitcnt vmcnt(8) lgkmcnt(2)
    v_mfma_f32_32x32x16_bf16 v[36:51], v[76:79], a[60:63], v[36:51]
    s_waitcnt lgkmcnt(0)
    v_mfma_f32_32x32x16_bf16 v[20:35], v[80:83], a[60:63], v[20:35]
    s_nop 9
    ds_write_b128 v248, v[36:39] offset:16384
    ds_write_b128 v248, v[40:43] offset:17408
    ds_write_b128 v248, v[44:47] offset:18432
    ds_write_b128 v248, v[48:51] offset:19456
    v_lshlrev_b32 v248, 3, v251
    s_waitcnt lgkmcnt(0)
    s_barrier
    ds_read_b128 v[36:39], v247 offset:16384
    ds_read_b128 v[40:43], v247 offset:17408
    ds_read_b128 v[44:47], v247 offset:18432
    ds_read_b128 v[48:51], v247 offset:19456
    s_waitcnt lgkmcnt(3)
    v_pk_add_f32 v[20:21], v[20:21], v[36:37]
    v_pk_add_f32 v[22:23], v[22:23], v[38:39]
    s_waitcnt lgkmcnt(2)
    v_pk_add_f32 v[24:25], v[24:25], v[40:41]
    v_pk_add_f32 v[26:27], v[26:27], v[42:43]
    v_cvt_pk_bf16_f32 v4, v20, v21
    v_cvt_pk_bf16_f32 v5, v22, v23
    v_cvt_pk_bf16_f32 v6, v24, v25
    v_cvt_pk_bf16_f32 v7, v26, v27
    buffer_store_dwordx4 v[4:7], v240, s[28:31], s12 offen offset:0 sc1
    s_waitcnt lgkmcnt(1)
    v_pk_add_f32 v[28:29], v[28:29], v[44:45]
    v_pk_add_f32 v[30:31], v[30:31], v[46:47]
    s_waitcnt lgkmcnt(0)
    v_pk_add_f32 v[32:33], v[32:33], v[48:49]
    v_pk_add_f32 v[34:35], v[34:35], v[50:51]
    v_cvt_pk_bf16_f32 v8, v28, v29
    v_cvt_pk_bf16_f32 v9, v30, v31
    v_cvt_pk_bf16_f32 v10, v32, v33
    v_cvt_pk_bf16_f32 v11, v34, v35
    buffer_store_dwordx4 v[8:11], v240, s[28:31], s12 offen offset:1024 sc1
    v_pk_add_f32 v[36:37], v[20:21], v[22:23]
    v_pk_mul_f32 v[38:39], v[20:21], v[20:21]
    v_pk_add_f32 v[40:41], v[24:25], v[26:27]
    v_pk_mul_f32 v[42:43], v[22:23], v[22:23]
    v_pk_fma_f32 v[38:39], v[24:25], v[24:25], v[38:39]
    v_pk_fma_f32 v[42:43], v[26:27], v[26:27], v[42:43]
    v_pk_add_f32 v[36:37], v[36:37], v[28:29]
    v_pk_fma_f32 v[38:39], v[28:29], v[28:29], v[38:39]
    v_pk_add_f32 v[40:41], v[40:41], v[30:31]
    v_pk_fma_f32 v[42:43], v[30:31], v[30:31], v[42:43]
    v_pk_add_f32 v[36:37], v[36:37], v[32:33]
    v_pk_fma_f32 v[38:39], v[32:33], v[32:33], v[38:39]
    v_pk_add_f32 v[40:41], v[40:41], v[34:35]
    v_pk_fma_f32 v[42:43], v[34:35], v[34:35], v[42:43]
    v_pk_add_f32 v[36:37], v[36:37], v[40:41]
    v_pk_add_f32 v[38:39], v[38:39], v[42:43]
    v_add_f32 v36, v36, v37
    v_add_f32 v37, v38, v39
    v_mov_b32 v38, v36
    v_mov_b32 v39, v37
    s_nop 0
    v_permlane32_swap_b32 v36, v38
    v_permlane32_swap_b32 v37, v39
    v_add_f32 v36, v36, v38
    v_add_f32 v37, v37, v39
    s_mov_b64 exec, s[62:63]
    buffer_store_dwordx2 v[36:37], v248, s[28:31], s13 offen sc1
    s_mov_b64 exec, -1
    s_add_u32 m0, s52, 32768
    s_nop 0
    buffer_load_dwordx4 v242, s[24:27], s16 offen lds
    s_add_u32 m0, s52, 36864
    s_add_u32 s45, s16, 16384
    buffer_load_dwordx4 v242, s[24:27], s45 offen lds
    s_add_u32 m0, s52, 40960
    s_add_u32 s45, s16, 32768
    buffer_load_dwordx4 v242, s[24:27], s45 offen lds
    s_add_u32 m0, s52, 45056
    s_add_u32 s45, s16, 49152
    buffer_load_dwordx4 v242, s[24:27], s45 offen lds
    ds_read_b64_tr_b16 v[52:53], v224 offset:32768
    ds_read_b64_tr_b16 v[54:55], v224 offset:33792
    ds_read_b64_tr_b16 v[56:57], v225 offset:32768
    ds_read_b64_tr_b16 v[58:59], v225 offset:33792
    ds_read_b64_tr_b16 v[60:61], v224 offset:49152
    ds_read_b64_tr_b16 v[62:63], v224 offset:50176
    ds_read_b64_tr_b16 v[64:65], v225 offset:49152
    ds_read_b64_tr_b16 v[66:67], v225 offset:50176
    ds_read_b64_tr_b16 v[68:69], v224 offset:34816
    ds_read_b64_tr_b16 v[70:71], v224 offset:35840
    ds_read_b64_tr_b16 v[72:73], v225 offset:34816
    ds_read_b64_tr_b16 v[74:75], v225 offset:35840
    ds_read_b64_tr_b16 v[76:77], v224 offset:51200
    ds_read_b64_tr_b16 v[78:79], v224 offset:52224
    ds_read_b64_tr_b16 v[80:81], v225 offset:51200
    ds_read_b64_tr_b16 v[82:83], v225 offset:52224
    s_waitcnt lgkmcnt(14)
    v_mfma_f32_16x16x32_bf16 v[216:219], v[220:223], v[52:55], 0
    s_waitcnt lgkmcnt(12)
    v_mfma_f32_16x16x32_bf16 v[212:215], v[220:223], v[56:59], 0
    s_waitcnt lgkmcnt(10)
    v_mfma_f32_16x16x32_bf16 v[216:219], v[220:223], v[60:63], v[216:219]
    s_waitcnt lgkmcnt(8)
    v_mfma_f32_16x16x32_bf16 v[212:215], v[220:223], v[64:67], v[212:215]
    s_waitcnt lgkmcnt(6)
    v_mfma_f32_16x16x32_bf16 v[216:219], v[220:223], v[68:71], v[216:219]
    s_waitcnt lgkmcnt(4)
    v_mfma_f32_16x16x32_bf16 v[212:215], v[220:223], v[72:75], v[212:215]
    s_waitcnt lgkmcnt(2)
    v_mfma_f32_16x16x32_bf16 v[216:219], v[220:223], v[76:79], v[216:219]
    s_waitcnt lgkmcnt(0)
    v_mfma_f32_16x16x32_bf16 v[212:215], v[220:223], v[80:83], v[212:215]
    ds_read_b64_tr_b16 v[52:53], v227 offset:0
    ds_read_b64_tr_b16 v[54:55], v227 offset:256
    ds_read_b64_tr_b16 v[56:57], v227 offset:4096
    ds_read_b64_tr_b16 v[58:59], v227 offset:4352
    ds_read_b64_tr_b16 v[60:61], v227 offset:8192
    ds_read_b64_tr_b16 v[62:63], v227 offset:8448
    ds_read_b64_tr_b16 v[64:65], v227 offset:12288
    ds_read_b64_tr_b16 v[66:67], v227 offset:12544
    ds_read_b64_tr_b16 v[68:69], v227 offset:512
    ds_read_b64_tr_b16 v[70:71], v227 offset:768
    ds_read_b64_tr_b16 v[72:73], v227 offset:4608
    ds_read_b64_tr_b16 v[74:75], v227 offset:4864
    ds_read_b64_tr_b16 v[76:77], v227 offset:8704
    ds_read_b64_tr_b16 v[78:79], v227 offset:8960
    ds_read_b64_tr_b16 v[80:81], v227 offset:12800
    ds_read_b64_tr_b16 v[82:83], v227 offset:13056
    s_waitcnt lgkmcnt(14)
    v_mfma_f32_16x16x32_bf16 v[200:203], v[220:223], v[52:55], 0
    s_waitcnt lgkmcnt(12)
    v_mfma_f32_16x16x32_bf16 v[200:203], v[220:223], v[56:59], v[200:203]
    s_waitcnt lgkmcnt(10)
    v_mfma_f32_16x16x32_bf16 v[200:203], v[220:223], v[60:63], v[200:203]
    s_waitcnt lgkmcnt(8)
    v_mfma_f32_16x16x32_bf16 v[200:203], v[220:223], v[64:67], v[200:203]
    s_waitcnt lgkmcnt(6)
    v_mfma_f32_16x16x32_bf16 v[200:203], v[220:223], v[68:71], v[200:203]
    s_waitcnt lgkmcnt(4)
    v_mfma_f32_16x16x32_bf16 v[200:203], v[220:223], v[72:75], v[200:203]
    s_waitcnt lgkmcnt(2)
    v_mfma_f32_16x16x32_bf16 v[200:203], v[220:223], v[76:79], v[200:203]
    s_waitcnt lgkmcnt(0)
    v_mfma_f32_16x16x32_bf16 v[200:203], v[220:223], v[80:83], v[200:203]
    s_waitcnt vmcnt(4)
    s_add_u32 s45, s14, s49
    s_mov_b64 exec, 1
    s_cmp_eq_u32 s33, 0
    s_cbranch_scc1 L_wt_31
    buffer_store_dword v190, v191, s[28:31], s45 offen offset:512
L_wb_32:
    s_mov_b64 exec, -1
    v_and_b32 v243, 15, v252
    s_lshl_b32 s41, s3, 5
    v_add_lshl_u32 v243, v243, s41, 2
    s_lshl_b32 s12, s3, 15
    s_add_u32 s12, s12, s48
    s_add_u32 s12, s12, 131072
    s_add_u32 s13, s70, s48
    s_add_u32 s13, s13, 1114112
    v_lshlrev_b32 v241, 11, v250
    v_lshl_add_u32 v241, v251, 3, v241
    s_lshl2_add_u32 s42, s56, s55
    s_lshl_b32 s15, s42, 11
    s_add_u32 s15, s15, s12
    ds_read_b64_tr_b16 v[52:53], v224 offset:0
    ds_read_b64_tr_b16 v[54:55], v224 offset:1024
    ds_read_b64_tr_b16 v[56:57], v225 offset:0
    ds_read_b64_tr_b16 v[58:59], v225 offset:1024
    ds_read_b64_tr_b16 v[60:61], v224 offset:16384
    ds_read_b64_tr_b16 v[62:63], v224 offset:17408
    ds_read_b64_tr_b16 v[64:65], v225 offset:16384
    ds_read_b64_tr_b16 v[66:67], v225 offset:17408
    ds_read_b64_tr_b16 v[68:69], v224 offset:2048
    ds_read_b64_tr_b16 v[70:71], v224 offset:3072
    ds_read_b64_tr_b16 v[72:73], v225 offset:2048
    ds_read_b64_tr_b16 v[74:75], v225 offset:3072
    ds_read_b64_tr_b16 v[76:77], v224 offset:18432
    ds_read_b64_tr_b16 v[78:79], v224 offset:19456
    ds_read_b64_tr_b16 v[80:81], v225 offset:18432
    ds_read_b64_tr_b16 v[82:83], v225 offset:19456
    s_waitcnt lgkmcnt(14)
    v_mfma_f32_16x16x32_bf16 v[216:219], v[220:223], v[52:55], v[216:219]
    s_waitcnt lgkmcnt(12)
    v_mfma_f32_16x16x32_bf16 v[212:215], v[220:223], v[56:59], v[212:215]
    s_waitcnt lgkmcnt(10)
    v_mfma_f32_16x16x32_bf16 v[216:219], v[220:223], v[60:63], v[216:219]
    s_waitcnt lgkmcnt(8)
    v_mfma_f32_16x16x32_bf16 v[212:215], v[220:223], v[64:67], v[212:215]
    s_waitcnt lgkmcnt(6)
    v_mfma_f32_16x16x32_bf16 v[216:219], v[220:223], v[68:71], v[216:219]
    s_waitcnt lgkmcnt(4)
    v_mfma_f32_16x16x32_bf16 v[212:215], v[220:223], v[72:75], v[212:215]
    s_waitcnt lgkmcnt(2)
    v_mfma_f32_16x16x32_bf16 v[216:219], v[220:223], v[76:79], v[216:219]
    s_waitcnt lgkmcnt(0)
    v_mfma_f32_16x16x32_bf16 v[212:215], v[220:223], v[80:83], v[212:215]
    buffer_load_dword v189, v243, s[28:31], s49 offen offset:512 sc1
    v_lshl_or_b32 v197, v232, 16, v232
    v_mov_b32 v198, 0
    v_mov_b32 v199, 0
    v_lshl_or_b32 v193, v233, 16, v233
    v_mov_b32 v194, 0
    v_mov_b32 v195, 0
    v_lshl_or_b32 v185, v234, 16, v234
    v_mov_b32 v186, 0
    v_mov_b32 v187, 0
    v_lshl_or_b32 v173, v235, 16, v235
    v_mov_b32 v174, 0
    v_mov_b32 v175, 0
    v_mov_b32 v52, v216
    v_mov_b32 v53, v212
    v_mov_b32 v54, v204
    v_mov_b32 v55, v200
    ds_write_b128 v247, v[52:55] offset:16384
    s_waitcnt lgkmcnt(0)
    s_barrier
    s_waitcnt vmcnt(0)
    v_cmp_ne_u32 vcc, s47, v189
    s_cbranch_vccnz L_slow_33
L_back_35:
    buffer_load_dwordx2 v[4:5], v241, s[28:31], s13 offen offset:0 sc1
    buffer_load_dwordx2 v[6:7], v241, s[28:31], s13 offen offset:256 sc1
    buffer_load_dwordx2 v[8:9], v241, s[28:31], s13 offen offset:512 sc1
    buffer_load_dwordx2 v[10:11], v241, s[28:31], s13 offen offset:768 sc1
    buffer_load_dwordx2 v[12:13], v241, s[28:31], s13 offen offset:1024 sc1
    buffer_load_dwordx2 v[14:15], v241, s[28:31], s13 offen offset:1280 sc1
    buffer_load_dwordx2 v[16:17], v241, s[28:31], s13 offen offset:1536 sc1
    buffer_load_dwordx2 v[18:19], v241, s[28:31], s13 offen offset:1792 sc1
    buffer_load_dwordx4 a[0:3], v240, s[28:31], s12 offen offset:0 sc1
    buffer_load_dwordx4 a[4:7], v240, s[28:31], s12 offen offset:1024 sc1
    buffer_load_dwordx4 a[8:11], v240, s[28:31], s12 offen offset:2048 sc1
    buffer_load_dwordx4 a[12:15], v240, s[28:31], s12 offen offset:3072 sc1
    s_add_u32 s12, s12, 4096
    buffer_load_dwordx4 a[16:19], v240, s[28:31], s12 offen offset:0 sc1
    buffer_load_dwordx4 a[20:23], v240, s[28:31], s12 offen offset:1024 sc1
    ds_read_b128 v[216:219], v240 offset:16384
    ds_read_b128 v[212:215], v240 offset:20480
    ds_read_b128 v[204:207], v240 offset:24576
    ds_read_b128 v[200:203], v240 offset:28672
    s_waitcnt lgkmcnt(2)
    v_pk_add_f32 v[216:217], v[216:217], v[212:213]
    v_pk_add_f32 v[218:219], v[218:219], v[214:215]
    s_waitcnt lgkmcnt(0)
    v_pk_add_f32 v[204:205], v[204:205], v[200:201]
    v_pk_add_f32 v[206:207], v[206:207], v[202:203]
    v_pk_add_f32 v[216:217], v[216:217], v[204:205]
    v_pk_add_f32 v[218:219], v[218:219], v[206:207]
    v_cvt_pk_bf16_f32 v246, v216, v216
    v_and_b32 v246, 0xffff0000, v246
    v_sub_f32 v246, v216, v246
    v_cvt_pk_bf16_f32 v196, v216, v246
    v_cvt_pk_bf16_f32 v246, v217, v217
    v_and_b32 v246, 0xffff0000, v246
    v_sub_f32 v246, v217, v246
    v_cvt_pk_bf16_f32 v192, v217, v246
    v_cvt_pk_bf16_f32 v246, v218, v218
    v_and_b32 v246, 0xffff0000, v246
    v_sub_f32 v246, v218, v246
    v_cvt_pk_bf16_f32 v184, v218, v246
    v_cvt_pk_bf16_f32 v246, v219, v219
    v_and_b32 v246, 0xffff0000, v246
    v_sub_f32 v246, v219, v246
    v_cvt_pk_bf16_f32 v172, v219, v246
    s_waitcnt vmcnt(12)
    v_pk_add_f32 v[4:5], v[4:5], v[6:7]
    s_waitcnt vmcnt(10)
    v_pk_add_f32 v[8:9], v[8:9], v[10:11]
    s_waitcnt vmcnt(8)
    v_pk_add_f32 v[12:13], v[12:13], v[14:15]
    s_waitcnt vmcnt(6)
    v_pk_add_f32 v[16:17], v[16:17], v[18:19]
    v_pk_add_f32 v[4:5], v[4:5], v[8:9]
    v_pk_add_f32 v[12:13], v[12:13], v[16:17]
    v_pk_add_f32 v[4:5], v[4:5], v[12:13]
    v_mov_b32 v6, v4
    v_mov_b32 v7, v5
    s_nop 0
    v_permlane32_swap_b32 v4, v6
    v_permlane32_swap_b32 v5, v7
    v_add_f32 v4, v4, v6
    v_add_f32 v5, v5, v7
    v_mul_f32 v4, 0xbb000000, v4
    v_mul_f32 v5, 0x3b000000, v5
    v_cvt_pk_bf16_f32 v248, v4, v4
    v_fma_f32 v5, -v4, v4, v5
    v_and_b32 v249, 0xffff0000, v248
    v_max_f32 v5, 0, v5
    v_sub_f32 v249, v4, v249
    v_add_f32 v5, 0x3727c5ac, v5
    v_cvt_pk_bf16_f32 v249, v249, v249
    v_rsq_f32 v236, v5
    v_cndmask_b32 v208, v249, v248, s[62:63]
    v_mul_f32 v238, v5, v236
    v_cvt_pk_bf16_f32 v248, v238, v238
    v_and_b32 v248, 0xffff0000, v248
    v_sub_f32 v249, v238, v248
    v_cvt_pk_bf16_f32 v248, v238, v249
    v_and_b32 v246, 0xffff0000, v248
    v_sub_f32 v249, v249, v246
    v_cvt_pk_bf16_f32 v249, v249, 0
    v_cndmask_b32 v209, v249, v248, s[62:63]
    v_mul_f32 v234, 1069066811, v236
    v_mul_f32 v232, -2.0, v236
    ds_read_b64_tr_b16 v[52:53], v228 offset:0
    ds_read_b64_tr_b16 v[54:55], v228 offset:1024
    ds_read_b64_tr_b16 v[56:57], v229 offset:0
    ds_read_b64_tr_b16 v[58:59], v229 offset:1024
    ds_read_b64_tr_b16 v[60:61], v228 offset:2048
    ds_read_b64_tr_b16 v[62:63], v228 offset:3072
    ds_read_b64_tr_b16 v[64:65], v229 offset:2048
    ds_read_b64_tr_b16 v[66:67], v229 offset:3072
    v_mfma_f32_32x32x16_bf16 v[4:19], v[196:199], v[208:211], 0
    buffer_load_dwordx4 a[24:27], v240, s[28:31], s12 offen offset:2048 sc1
    v_mfma_f32_32x32x16_bf16 v[28:43], v[192:195], v[208:211], 0
    ds_read_b64_tr_b16 v[68:69], v228 offset:4096
    ds_read_b64_tr_b16 v[70:71], v228 offset:5120
    s_waitcnt vmcnt(6) lgkmcnt(8)
    v_mfma_f32_32x32x16_bf16 v[4:19], v[52:55], a[0:3], v[4:19]
    buffer_load_dwordx4 a[28:31], v240, s[28:31], s12 offen offset:3072 sc1
    ds_read_b64_tr_b16 v[72:73], v229 offset:4096
    ds_read_b64_tr_b16 v[74:75], v229 offset:5120
    s_waitcnt lgkmcnt(8)
    v_mfma_f32_32x32x16_bf16 v[28:43], v[56:59], a[0:3], v[28:43]
    ds_read_b64_tr_b16 v[76:77], v228 offset:6144
    ds_read_b64_tr_b16 v[78:79], v228 offset:7168
    s_waitcnt vmcnt(6) lgkmcnt(8)
    v_mfma_f32_32x32x16_bf16 v[4:19], v[60:63], a[4:7], v[4:19]
    s_add_u32 s12, s12, 4096
    buffer_load_dwordx4 a[32:35], v240, s[28:31], s12 offen offset:0 sc1
    ds_read_b64_tr_b16 v[80:81], v229 offset:6144
    ds_read_b64_tr_b16 v[82:83], v229 offset:7168
    s_waitcnt lgkmcnt(8)
    v_mfma_f32_32x32x16_bf16 v[28:43], v[64:67], a[4:7], v[28:43]
    ds_read_b64_tr_b16 v[52:53], v228 offset:8192
    ds_read_b64_tr_b16 v[54:55], v228 offset:9216
    s_waitcnt vmcnt(6) lgkmcnt(8)
    v_mfma_f32_32x32x16_bf16 v[4:19], v[68:71], a[8:11], v[4:19]
    buffer_load_dwordx4 a[36:39], v240, s[28:31], s12 offen offset:1024 sc1
    ds_read_b64_tr_b16 v[56:57], v229 offset:8192
    ds_read_b64_tr_b16 v[58:59], v229 offset:9216
    s_waitcnt lgkmcnt(8)
    v_mfma_f32_32x32x16_bf16 v[28:43], v[72:75], a[8:11], v[28:43]
    ds_read_b64_tr_b16 v[60:61], v228 offset:10240
    ds_read_b64_tr_b16 v[62:63], v228 offset:11264
    s_waitcnt vmcnt(6) lgkmcnt(8)
    v_mfma_f32_32x32x16_bf16 v[4:19], v[76:79], a[12:15], v[4:19]
    buffer_load_dwordx4 a[40:43], v240, s[28:31], s12 offen offset:2048 sc1
    ds_read_b64_tr_b16 v[64:65], v229 offset:10240
    ds_read_b64_tr_b16 v[66:67], v229 offset:11264
    s_waitcnt lgkmcnt(8)
    v_mfma_f32_32x32x16_bf16 v[28:43], v[80:83], a[12:15], v[28:43]
    ds_read_b64_tr_b16 v[68:69], v228 offset:12288
    ds_read_b64_tr_b16 v[70:71], v228 offset:13312
    s_waitcnt vmcnt(6) lgkmcnt(8)
    v_mfma_f32_32x32x16_bf16 v[4:19], v[52:55], a[16:19], v[4:19]
    buffer_load_dwordx4 a[44:47], v240, s[28:31], s12 offen offset:3072 sc1
    ds_read_b64_tr_b16 v[72:73], v229 offset:12288
    ds_read_b64_tr_b16 v[74:75], v229 offset:13312
    s_waitcnt lgkmcnt(8)
    v_mfma_f32_32x32x16_bf16 v[28:43], v[56:59], a[16:19], v[28:43]
    ds_read_b64_tr_b16 v[76:77], v228 offset:14336
    ds_read_b64_tr_b16 v[78:79], v228 offset:15360
    s_waitcnt vmcnt(6) lgkmcnt(8)
    v_mfma_f32_32x32x16_bf16 v[4:19], v[60:63], a[20:23], v[4:19]
    s_add_u32 s12, s12, 4096
    buffer_load_dwordx4 a[48:51], v240, s[28:31], s12 offen offset:0 sc1
    ds_read_b64_tr_b16 v[80:81], v229 offset:14336
    ds_read_b64_tr_b16 v[82:83], v229 offset:15360
    s_waitcnt lgkmcnt(8)
    v_mfma_f32_32x32x16_bf16 v[28:43], v[64:67], a[20:23], v[28:43]
    ds_read_b64_tr_b16 v[52:53], v228 offset:16384
    ds_read_b64_tr_b16 v[54:55], v228 offset:17408
    s_waitcnt vmcnt(6) lgkmcnt(8)
    v_mfma_f32_32x32x16_bf16 v[4:19], v[68:71], a[24:27], v[4:19]
    buffer_load_dwordx4 a[52:55], v240, s[28:31], s12 offen offset:1024 sc1
    ds_read_b64_tr_b16 v[56:57], v229 offset:16384
    ds_read_b64_tr_b16 v[58:59], v229 offset:17408
    s_waitcnt lgkmcnt(8)
    v_mfma_f32_32x32x16_bf16 v[28:43], v[72:75], a[24:27], v[28:43]
    ds_read_b64_tr_b16 v[60:61], v228 offset:18432
    ds_read_b64_tr_b16 v[62:63], v228 offset:19456
    s_waitcnt vmcnt(6) lgkmcnt(8)
    v_mfma_f32_32x32x16_bf16 v[4:19], v[76:79], a[28:31], v[4:19]
    buffer_load_dwordx4 a[56:59], v240, s[28:31], s12 offen offset:2048 sc1
    ds_read_b64_tr_b16 v[64:65], v229 offset:18432
    ds_read_b64_tr_b16 v[66:67], v229 offset:19456
    s_waitcnt lgkmcnt(8)
    v_mfma_f32_32x32x16_bf16 v[28:43], v[80:83], a[28:31], v[28:43]
    ds_read_b64_tr_b16 v[68:69], v228 offset:20480
    ds_read_b64_tr_b16 v[70:71], v228 offset:21504
    s_waitcnt vmcnt(6) lgkmcnt(8)
    v_mfma_f32_32x32x16_bf16 v[4:19], v[52:55], a[32:35], v[4:19]
    buffer_load_dwordx4 a[60:63], v240, s[28:31], s12 offen offset:3072 sc1
    ds_read_b64_tr_b16 v[72:73], v229 offset:20480
    ds_read_b64_tr_b16 v[74:75], v229 offset:21504
    s_waitcnt lgkmcnt(8)
    v_mfma_f32_32x32x16_bf16 v[28:43], v[56:59], a[32:35], v[28:43]
    ds_read_b64_tr_b16 v[76:77], v228 offset:22528
    ds_read_b64_tr_b16 v[78:79], v228 offset:23552
    s_waitcnt vmcnt(6) lgkmcnt(8)
    v_mfma_f32_32x32x16_bf16 v[4:19], v[60:63], a[36:39], v[4:19]
    s_add_u32 s12, s12, 4096
    buffer_load_dwordx4 a[64:67], v240, s[28:31], s12 offen offset:0 sc1
    ds_read_b64_tr_b16 v[80:81], v229 offset:22528
    ds_read_b64_tr_b16 v[82:83], v229 offset:23552
    s_waitcnt lgkmcnt(8)
    v_mfma_f32_32x32x16_bf16 v[28:43], v[64:67], a[36:39], v[28:43]
    ds_read_b64_tr_b16 v[52:53], v228 offset:24576
    ds_read_b64_tr_b16 v[54:55], v228 offset:25600
    s_waitcnt vmcnt(6) lgkmcnt(8)
    v_mfma_f32_32x32x16_bf16 v[4:19], v[68:71], a[40:43], v[4:19]
    buffer_load_dwordx4 a[68:71], v240, s[28:31], s12 offen offset:1024 sc1
    ds_read_b64_tr_b16 v[56:57], v229 offset:24576
    ds_read_b64_tr_b16 v[58:59], v229 offset:25600
    s_waitcnt lgkmcnt(8)
    v_mfma_f32_32x32x16_bf16 v[28:43], v[72:75], a[40:43], v[28:43]
    ds_read_b64_tr_b16 v[60:61], v228 offset:26624
    ds_read_b64_tr_b16 v[62:63], v228 offset:27648
    s_waitcnt vmcnt(6) lgkmcnt(8)
    v_mfma_f32_32x32x16_bf16 v[4:19], v[76:79], a[44:47], v[4:19]
    buffer_load_dwordx4 a[72:75], v240, s[28:31], s12 offen offset:2048 sc1
    ds_read_b64_tr_b16 v[64:65], v229 offset:26624
    ds_read_b64_tr_b16 v[66:67], v229 offset:27648
    s_waitcnt lgkmcnt(8)
    v_mfma_f32_32x32x16_bf16 v[28:43], v[80:83], a[44:47], v[28:43]
    ds_read_b64_tr_b16 v[68:69], v228 offset:28672
    ds_read_b64_tr_b16 v[70:71], v228 offset:29696
    s_waitcnt vmcnt(6) lgkmcnt(8)
    v_mfma_f32_32x32x16_bf16 v[4:19], v[52:55], a[48:51], v[4:19]
    buffer_load_dwordx4 a[76:79], v240, s[28:31], s12 offen offset:3072 sc1
    ds_read_b64_tr_b16 v[72:73], v229 offset:28672
    ds_read_b64_tr_b16 v[74:75], v229 offset:29696
    s_waitcnt lgkmcnt(8)
    v_mfma_f32_32x32x16_bf16 v[28:43], v[56:59], a[48:51], v[28:43]
    ds_read_b64_tr_b16 v[76:77], v228 offset:30720
    ds_read_b64_tr_b16 v[78:79], v228 offset:31744
    s_waitcnt vmcnt(6) lgkmcnt(8)
    v_mfma_f32_32x32x16_bf16 v[4:19], v[60:63], a[52:55], v[4:19]
    s_add_u32 s12, s12, 4096
    buffer_load_dwordx4 a[80:83], v240, s[28:31], s12 offen offset:0 sc1
    ds_read_b64_tr_b16 v[80:81], v229 offset:30720
    ds_read_b64_tr_b16 v[82:83], v229 offset:31744
    s_waitcnt lgkmcnt(8)
    v_mfma_f32_32x32x16_bf16 v[28:43], v[64:67], a[52:55], v[28:43]
    ds_read_b64_tr_b16 v[52:53], v228 offset:32768
    ds_read_b64_tr_b16 v[54:55], v228 offset:33792
    s_waitcnt vmcnt(6) lgkmcnt(8)
    v_mfma_f32_32x32x16_bf16 v[4:19], v[68:71], a[56:59], v[4:19]
    buffer_load_dwordx4 a[84:87], v240, s[28:31], s12 offen offset:1024 sc1
    ds_read_b64_tr_b16 v[56:57], v229 offset:32768
    ds_read_b64_tr_b16 v[58:59], v229 offset:33792
    s_waitcnt lgkmcnt(8)
    v_mfma_f32_32x32x16_bf16 v[28:43], v[72:75], a[56:59], v[28:43]
    ds_read_b64_tr_b16 v[60:61], v228 offset:34816
    ds_read_b64_tr_b16 v[62:63], v228 offset:35840
    s_waitcnt vmcnt(6) lgkmcnt(8)
    v_mfma_f32_32x32x16_bf16 v[4:19], v[76:79], a[60:63], v[4:19]
    buffer_load_dwordx4 a[88:91], v240, s[28:31], s12 offen offset:2048 sc1
    ds_read_b64_tr_b16 v[64:65], v229 offset:34816
    ds_read_b64_tr_b16 v[66:67], v229 offset:35840
    s_waitcnt lgkmcnt(8)
    v_mfma_f32_32x32x16_bf16 v[28:43], v[80:83], a[60:63], v[28:43]
    ds_read_b64_tr_b16 v[68:69], v228 offset:36864
    ds_read_b64_tr_b16 v[70:71], v228 offset:37888
    s_waitcnt vmcnt(6) lgkmcnt(8)
    v_mfma_f32_32x32x16_bf16 v[4:19], v[52:55], a[64:67], v[4:19]
    buffer_load_dwordx4 a[92:95], v240, s[28:31], s12 offen offset:3072 sc1
    ds_read_b64_tr_b16 v[72:73], v229 offset:36864
    ds_read_b64_tr_b16 v[74:75], v229 offset:37888
    s_waitcnt lgkmcnt(8)
    v_mfma_f32_32x32x16_bf16 v[28:43], v[56:59], a[64:67], v[28:43]
    ds_read_b64_tr_b16 v[76:77], v228 offset:38912
    ds_read_b64_tr_b16 v[78:79], v228 offset:39936
    s_waitcnt vmcnt(6) lgkmcnt(8)
    v_mfma_f32_32x32x16_bf16 v[4:19], v[60:63], a[68:71], v[4:19]
    s_add_u32 s12, s12, 4096
    buffer_load_dwordx4 a[96:99], v240, s[28:31], s12 offen offset:0 sc1
    ds_read_b64_tr_b16 v[80:81], v229 offset:38912
    ds_read_b64_tr_b16 v[82:83], v229 offset:39936
    s_waitcnt lgkmcnt(8)
    v_mfma_f32_32x32x16_bf16 v[28:43], v[64:67], a[68:71], v[28:43]
    ds_read_b64_tr_b16 v[52:53], v228 offset:40960
    ds_read_b64_tr_b16 v[54:55], v228 offset:41984
    s_waitcnt vmcnt(6) lgkmcnt(8)
    v_mfma_f32_32x32x16_bf16 v[4:19], v[68:71], a[72:75], v[4:19]
    buffer_load_dwordx4 a[100:103], v240, s[28:31], s12 offen offset:1024 sc1
    ds_read_b64_tr_b16 v[56:57], v229 offset:40960
    ds_read_b64_tr_b16 v[58:59], v229 offset:41984
    s_waitcnt lgkmcnt(8)
    v_mfma_f32_32x32x16_bf16 v[28:43], v[72:75], a[72:75], v[28:43]
    ds_read_b64_tr_b16 v[60:61], v228 offset:43008
    ds_read_b64_tr_b16 v[62:63], v228 offset:44032
    s_waitcnt vmcnt(6) lgkmcnt(8)
    v_mfma_f32_32x32x16_bf16 v[4:19], v[76:79], a[76:79], v[4:19]
    buffer_load_dwordx4 a[104:107], v240, s[28:31], s12 offen offset:2048 sc1
    ds_read_b64_tr_b16 v[64:65], v229 offset:43008
    ds_read_b64_tr_b16 v[66:67], v229 offset:44032
    s_waitcnt lgkmcnt(8)
    v_mfma_f32_32x32x16_bf16 v[28:43], v[80:83], a[76:79], v[28:43]
    ds_read_b64_tr_b16 v[68:69], v228 offset:45056
    ds_read_b64_tr_b16 v[70:71], v228 offset:46080
    s_waitcnt vmcnt(6) lgkmcnt(8)
    v_mfma_f32_32x32x16_bf16 v[4:19], v[52:55], a[80:83], v[4:19]
    buffer_load_dwordx4 a[108:111], v240, s[28:31], s12 offen offset:3072 sc1
    ds_read_b64_tr_b16 v[72:73], v229 offset:45056
    ds_read_b64_tr_b16 v[74:75], v229 offset:46080
    s_waitcnt lgkmcnt(8)
    v_mfma_f32_32x32x16_bf16 v[28:43], v[56:59], a[80:83], v[28:43]
    ds_read_b64_tr_b16 v[76:77], v228 offset:47104
    ds_read_b64_tr_b16 v[78:79], v228 offset:48128
    s_waitcnt vmcnt(6) lgkmcnt(8)
    v_mfma_f32_32x32x16_bf16 v[4:19], v[60:63], a[84:87], v[4:19]
    s_add_u32 s12, s12, 4096
    buffer_load_dwordx4 a[112:115], v240, s[28:31], s12 offen offset:0 sc1
    ds_read_b64_tr_b16 v[80:81], v229 offset:47104
    ds_read_b64_tr_b16 v[82:83], v229 offset:48128
    s_waitcnt lgkmcnt(8)
    v_mfma_f32_32x32x16_bf16 v[28:43], v[64:67], a[84:87], v[28:43]
    ds_read_b64_tr_b16 v[52:53], v228 offset:49152
    ds_read_b64_tr_b16 v[54:55], v228 offset:50176
    s_waitcnt vmcnt(6) lgkmcnt(8)
    v_mfma_f32_32x32x16_bf16 v[4:19], v[68:71], a[88:91], v[4:19]
    buffer_load_dwordx4 a[116:119], v240, s[28:31], s12 offen offset:1024 sc1
    ds_read_b64_tr_b16 v[56:57], v229 offset:49152
    ds_read_b64_tr_b16 v[58:59], v229 offset:50176
    s_waitcnt lgkmcnt(8)
    v_mfma_f32_32x32x16_bf16 v[28:43], v[72:75], a[88:91], v[28:43]
    ds_read_b64_tr_b16 v[60:61], v228 offset:51200
    ds_read_b64_tr_b16 v[62:63], v228 offset:52224
    s_waitcnt vmcnt(6) lgkmcnt(8)
    v_mfma_f32_32x32x16_bf16 v[4:19], v[76:79], a[92:95], v[4:19]
    buffer_load_dwordx4 a[120:123], v240, s[28:31], s12 offen offset:2048 sc1
    ds_read_b64_tr_b16 v[64:65], v229 offset:51200
    ds_read_b64_tr_b16 v[66:67], v229 offset:52224
    s_waitcnt lgkmcnt(8)
    v_mfma_f32_32x32x16_bf16 v[28:43], v[80:83], a[92:95], v[28:43]
    ds_read_b64_tr_b16 v[68:69], v228 offset:53248
    ds_read_b64_tr_b16 v[70:71], v228 offset:54272
    s_waitcnt vmcnt(6) lgkmcnt(8)
    v_mfma_f32_32x32x16_bf16 v[4:19], v[52:55], a[96:99], v[4:19]
    buffer_load_dwordx4 a[124:127], v240, s[28:31], s12 offen offset:3072 sc1
    ds_read_b64_tr_b16 v[72:73], v229 offset:53248
    ds_read_b64_tr_b16 v[74:75], v229 offset:54272
    s_waitcnt lgkmcnt(8)
    v_mfma_f32_32x32x16_bf16 v[28:43], v[56:59], a[96:99], v[28:43]
    ds_read_b64_tr_b16 v[76:77], v228 offset:55296
    ds_read_b64_tr_b16 v[78:79], v228 offset:56320
    s_waitcnt vmcnt(6) lgkmcnt(8)
    v_mfma_f32_32x32x16_bf16 v[4:19], v[60:63], a[100:103], v[4:19]
    buffer_load_dwordx4 v[20:23], v240, s[28:31], s15 offen sc1
    ds_read_b64_tr_b16 v[80:81], v229 offset:55296
    ds_read_b64_tr_b16 v[82:83], v229 offset:56320
    s_waitcnt lgkmcnt(8)
    v_mfma_f32_32x32x16_bf16 v[28:43], v[64:67], a[100:103], v[28:43]
    s_add_u32 m0, s52, 49152
    s_nop 0
    buffer_load_dwordx4 v242, s[24:27], s17 offen lds
    ds_read_b64_tr_b16 v[52:53], v228 offset:57344
    ds_read_b64_tr_b16 v[54:55], v228 offset:58368
    s_waitcnt vmcnt(7) lgkmcnt(8)
    v_mfma_f32_32x32x16_bf16 v[4:19], v[68:71], a[104:107], v[4:19]
    buffer_load_dwordx4 v[24:27], v240, s[28:31], s15 offen offset:1024 sc1
    ds_read_b64_tr_b16 v[56:57], v229 offset:57344
    ds_read_b64_tr_b16 v[58:59], v229 offset:58368
    s_waitcnt lgkmcnt(8)
    v_mfma_f32_32x32x16_bf16 v[28:43], v[72:75], a[104:107], v[28:43]
    ds_read_b64_tr_b16 v[60:61], v228 offset:59392
    ds_read_b64_tr_b16 v[62:63], v228 offset:60416
    s_waitcnt vmcnt(7) lgkmcnt(8)
    v_mfma_f32_32x32x16_bf16 v[4:19], v[76:79], a[108:111], v[4:19]
    s_add_u32 m0, s52, 53248
    s_add_u32 s45, s17, 16384
    buffer_load_dwordx4 v242, s[24:27], s45 offen lds
    ds_read_b64_tr_b16 v[64:65], v229 offset:59392
    ds_read_b64_tr_b16 v[66:67], v229 offset:60416
    s_waitcnt lgkmcnt(8)
    v_mfma_f32_32x32x16_bf16 v[28:43], v[80:83], a[108:111], v[28:43]
    ds_read_b64_tr_b16 v[68:69], v228 offset:61440
    ds_read_b64_tr_b16 v[70:71], v228 offset:62464
    s_waitcnt vmcnt(7) lgkmcnt(8)
    v_mfma_f32_32x32x16_bf16 v[4:19], v[52:55], a[112:115], v[4:19]
    ds_read_b64_tr_b16 v[72:73], v229 offset:61440
    ds_read_b64_tr_b16 v[74:75], v229 offset:62464
    s_waitcnt lgkmcnt(8)
    v_mfma_f32_32x32x16_bf16 v[28:43], v[56:59], a[112:115], v[28:43]
    ds_read_b64_tr_b16 v[76:77], v228 offset:63488
    ds_read_b64_tr_b16 v[78:79], v228 offset:64512
    s_waitcnt vmcnt(6) lgkmcnt(8)
    v_mfma_f32_32x32x16_bf16 v[4:19], v[60:63], a[116:119], v[4:19]
    s_add_u32 m0, s52, 57344
    s_nop 0
    buffer_load_dwordx4 v242, s[24:27], s18 offen lds
    ds_read_b64_tr_b16 v[80:81], v229 offset:63488
    ds_read_b64_tr_b16 v[82:83], v229 offset:64512
    s_waitcnt lgkmcnt(8)
    v_mfma_f32_32x32x16_bf16 v[28:43], v[64:67], a[116:119], v[28:43]
    s_waitcnt vmcnt(6) lgkmcnt(6)
    v_mfma_f32_32x32x16_bf16 v[4:19], v[68:71], a[120:123], v[4:19]
    s_waitcnt lgkmcnt(4)
    v_mfma_f32_32x32x16_bf16 v[28:43], v[72:75], a[120:123], v[28:43]
    s_waitcnt vmcnt(5) lgkmcnt(2)
    v_mfma_f32_32x32x16_bf16 v[4:19], v[76:79], a[124:127], v[4:19]
    s_add_u32 m0, s52, 61440
    s_nop 0
    buffer_load_dwordx4 v242, s[24:27], s19 offen lds
    s_waitcnt lgkmcnt(0)
    v_mfma_f32_32x32x16_bf16 v[28:43], v[80:83], a[124:127], v[28:43]
    s_barrier
    s_lshl_b32 s41, s3, 7
    s_lshl2_add_u32 s34, s32, s41
    s_lshl_b32 s41, s3, 5
    s_lshl2_add_u32 s41, s55, s41
    v_add_lshl_u32 v243, v245, s41, 2
    s_nop 0
    v_pk_mul_f32 v[144:145], v[4:5], v[234:235] op_sel_hi:[1,0]
    v_pk_mul_f32 v[146:147], v[6:7], v[234:235] op_sel_hi:[1,0]
    v_pk_mul_f32 v[148:149], v[8:9], v[234:235] op_sel_hi:[1,0]
    v_pk_mul_f32 v[150:151], v[10:11], v[234:235] op_sel_hi:[1,0]
    v_exp_f32 v144, v144
    v_exp_f32 v145, v145
    v_exp_f32 v146, v146
    v_exp_f32 v147, v147
    s_add_u32 m0, s52, 65536
    s_add_u32 s45, s19, 16384
    buffer_load_dwordx4 v242, s[24:27], s45 offen lds
    v_exp_f32 v148, v148
    v_exp_f32 v149, v149
    v_exp_f32 v150, v150
    v_exp_f32 v151, v151
    v_pk_add_f32 v[152:153], v[144:145], 2.0 op_sel_hi:[1,0]
    v_pk_add_f32 v[154:155], v[146:147], 2.0 op_sel_hi:[1,0]
    v_pk_add_f32 v[156:157], v[148:149], 2.0 op_sel_hi:[1,0]
    v_pk_add_f32 v[158:159], v[150:151], 2.0 op_sel_hi:[1,0]
    v_pk_fma_f32 v[152:153], v[152:153], v[144:145], 2.0 op_sel_hi:[1,1,0]
    v_pk_fma_f32 v[154:155], v[154:155], v[146:147], 2.0 op_sel_hi:[1,1,0]
    v_pk_fma_f32 v[156:157], v[156:157], v[148:149], 2.0 op_sel_hi:[1,1,0]
    v_pk_fma_f32 v[158:159], v[158:159], v[150:151], 2.0 op_sel_hi:[1,1,0]
    v_rcp_f32 v152, v152
    v_rcp_f32 v153, v153
    v_rcp_f32 v154, v154
    v_rcp_f32 v155, v155
    v_rcp_f32 v156, v156
    v_rcp_f32 v157, v157
    v_rcp_f32 v158, v158
    s_add_u32 m0, s52, 69632
    s_add_u32 s45, s19, 32768
    buffer_load_dwordx4 v242, s[24:27], s45 offen lds
    v_rcp_f32 v159, v159
    v_pk_fma_f32 v[152:153], v[152:153], v[232:233], v[236:237] op_sel_hi:[1,0,0]
    v_pk_fma_f32 v[154:155], v[154:155], v[232:233], v[236:237] op_sel_hi:[1,0,0]
    v_pk_fma_f32 v[156:157], v[156:157], v[232:233], v[236:237] op_sel_hi:[1,0,0]
    v_pk_fma_f32 v[158:159], v[158:159], v[232:233], v[236:237] op_sel_hi:[1,0,0]
    v_pk_mul_f32 v[152:153], v[152:153], v[4:5]
    v_pk_mul_f32 v[154:155], v[154:155], v[6:7]
    v_pk_mul_f32 v[156:157], v[156:157], v[8:9]
    v_pk_mul_f32 v[158:159], v[158:159], v[10:11]
    v_cvt_pk_bf16_f32 v116, v152, v153
    v_cvt_pk_bf16_f32 v117, v154, v155
    v_cvt_pk_bf16_f32 v118, v156, v157
    v_cvt_pk_bf16_f32 v119, v158, v159
    buffer_store_dwordx4 v[116:119], v240, s[28:31], s72 offen offset:0 sc1
    v_pk_mul_f32 v[144:145], v[12:13], v[234:235] op_sel_hi:[1,0]
    v_pk_mul_f32 v[146:147], v[14:15], v[234:235] op_sel_hi:[1,0]
    v_pk_mul_f32 v[148:149], v[16:17], v[234:235] op_sel_hi:[1,0]
    v_pk_mul_f32 v[150:151], v[18:19], v[234:235] op_sel_hi:[1,0]
    v_exp_f32 v144, v144
    v_exp_f32 v145, v145
    v_exp_f32 v146, v146
    v_exp_f32 v147, v147
    v_exp_f32 v148, v148
    v_exp_f32 v149, v149
    s_add_u32 m0, s52, 73728
    s_add_u32 s45, s19, 49152
    buffer_load_dwordx4 v242, s[24:27], s45 offen lds
    v_exp_f32 v150, v150
    v_exp_f32 v151, v151
    v_pk_add_f32 v[152:153], v[144:145], 2.0 op_sel_hi:[1,0]
    v_pk_add_f32 v[154:155], v[146:147], 2.0 op_sel_hi:[1,0]
    v_pk_add_f32 v[156:157], v[148:149], 2.0 op_sel_hi:[1,0]
    v_pk_add_f32 v[158:159], v[150:151], 2.0 op_sel_hi:[1,0]
    v_pk_fma_f32 v[152:153], v[152:153], v[144:145], 2.0 op_sel_hi:[1,1,0]
    v_pk_fma_f32 v[154:155], v[154:155], v[146:147], 2.0 op_sel_hi:[1,1,0]
    v_pk_fma_f32 v[156:157], v[156:157], v[148:149], 2.0 op_sel_hi:[1,1,0]
    v_pk_fma_f32 v[158:159], v[158:159], v[150:151], 2.0 op_sel_hi:[1,1,0]
    v_rcp_f32 v152, v152
    v_rcp_f32 v153, v153
    v_rcp_f32 v154, v154
    v_rcp_f32 v155, v155
    v_rcp_f32 v156, v156
    v_rcp_f32 v157, v157
    v_rcp_f32 v158, v158
    v_rcp_f32 v159, v159
    v_pk_fma_f32 v[152:153], v[152:153], v[232:233], v[236:237] op_sel_hi:[1,0,0]
    v_pk_fma_f32 v[154:155], v[154:155], v[232:233], v[236:237] op_sel_hi:[1,0,0]
    v_pk_fma_f32 v[156:157], v[156:157], v[232:233], v[236:237] op_sel_hi:[1,0,0]
    s_add_u32 m0, s52, 77824
    s_nop 0
    buffer_load_dwordx4 v242, s[24:27], s38 offen lds
    v_pk_fma_f32 v[158:159], v[158:159], v[232:233], v[236:237] op_sel_hi:[1,0,0]
    v_pk_mul_f32 v[152:153], v[152:153], v[12:13]
    v_pk_mul_f32 v[154:155], v[154:155], v[14:15]
    v_pk_mul_f32 v[156:157], v[156:157], v[16:17]
    v_pk_mul_f32 v[158:159], v[158:159], v[18:19]
    v_cvt_pk_bf16_f32 v120, v152, v153
    v_cvt_pk_bf16_f32 v121, v154, v155
    v_cvt_pk_bf16_f32 v122, v156, v157
    v_cvt_pk_bf16_f32 v123, v158, v159
    buffer_store_dwordx4 v[120:123], v240, s[28:31], s72 offen offset:1024 sc1
    v_pk_mul_f32 v[144:145], v[28:29], v[234:235] op_sel_hi:[1,0]
    v_pk_mul_f32 v[146:147], v[30:31], v[234:235] op_sel_hi:[1,0]
    v_pk_mul_f32 v[148:149], v[32:33], v[234:235] op_sel_hi:[1,0]
    v_pk_mul_f32 v[150:151], v[34:35], v[234:235] op_sel_hi:[1,0]
    v_exp_f32 v144, v144
    v_exp_f32 v145, v145
    v_exp_f32 v146, v146
    v_exp_f32 v147, v147
    v_exp_f32 v148, v148
    v_exp_f32 v149, v149
    v_exp_f32 v150, v150
    v_exp_f32 v151, v151
    v_pk_add_f32 v[152:153], v[144:145], 2.0 op_sel_hi:[1,0]
    v_pk_add_f32 v[154:155], v[146:147], 2.0 op_sel_hi:[1,0]
    s_add_u32 m0, s52, 81920
    s_add_u32 s45, s38, 16384
    buffer_load_dwordx4 v242, s[24:27], s45 offen lds
    v_pk_add_f32 v[156:157], v[148:149], 2.0 op_sel_hi:[1,0]
    v_pk_add_f32 v[158:159], v[150:151], 2.0 op_sel_hi:[1,0]
    v_pk_fma_f32 v[152:153], v[152:153], v[144:145], 2.0 op_sel_hi:[1,1,0]
    v_pk_fma_f32 v[154:155], v[154:155], v[146:147], 2.0 op_sel_hi:[1,1,0]
    v_pk_fma_f32 v[156:157], v[156:157], v[148:149], 2.0 op_sel_hi:[1,1,0]
    v_pk_fma_f32 v[158:159], v[158:159], v[150:151], 2.0 op_sel_hi:[1,1,0]
    v_rcp_f32 v152, v152
    v_rcp_f32 v153, v153
    v_rcp_f32 v154, v154
    v_rcp_f32 v155, v155
    v_rcp_f32 v156, v156
    v_rcp_f32 v157, v157
    v_rcp_f32 v158, v158
    v_rcp_f32 v159, v159
    v_pk_fma_f32 v[152:153], v[152:153], v[232:233], v[236:237] op_sel_hi:[1,0,0]
    v_pk_fma_f32 v[154:155], v[154:155], v[232:233], v[236:237] op_sel_hi:[1,0,0]
    v_pk_fma_f32 v[156:157], v[156:157], v[232:233], v[236:237] op_sel_hi:[1,0,0]
    v_pk_fma_f32 v[158:159], v[158:159], v[232:233], v[236:237] op_sel_hi:[1,0,0]
    v_pk_mul_f32 v[152:153], v[152:153], v[28:29]
    v_pk_mul_f32 v[154:155], v[154:155], v[30:31]
    v_pk_mul_f32 v[156:157], v[156:157], v[32:33]
    v_pk_mul_f32 v[158:159], v[158:159], v[34:35]
    v_cvt_pk_bf16_f32 v124, v152, v153
    s_add_u32 m0, s52, 86016
    s_add_u32 s45, s38, 32768
    buffer_load_dwordx4 v242, s[24:27], s45 offen lds
    v_cvt_pk_bf16_f32 v125, v154, v155
    v_cvt_pk_bf16_f32 v126, v156, v157
    v_cvt_pk_bf16_f32 v127, v158, v159
    buffer_store_dwordx4 v[124:127], v240, s[28:31], s72 offen offset:2048 sc1
    v_pk_mul_f32 v[144:145], v[36:37], v[234:235] op_sel_hi:[1,0]
    v_pk_mul_f32 v[146:147], v[38:39], v[234:235] op_sel_hi:[1,0]
    v_pk_mul_f32 v[148:149], v[40:41], v[234:235] op_sel_hi:[1,0]
    v_pk_mul_f32 v[150:151], v[42:43], v[234:235] op_sel_hi:[1,0]
    v_exp_f32 v144, v144
    v_exp_f32 v145, v145
    v_exp_f32 v146, v146
    v_exp_f32 v147, v147
    v_exp_f32 v148, v148
    v_exp_f32 v149, v149
    v_exp_f32 v150, v150
    v_exp_f32 v151, v151
    v_pk_add_f32 v[152:153], v[144:145], 2.0 op_sel_hi:[1,0]
    v_pk_add_f32 v[154:155], v[146:147], 2.0 op_sel_hi:[1,0]
    v_pk_add_f32 v[156:157], v[148:149], 2.0 op_sel_hi:[1,0]
    v_pk_add_f32 v[158:159], v[150:151], 2.0 op_sel_hi:[1,0]
    v_pk_fma_f32 v[152:153], v[152:153], v[144:145], 2.0 op_sel_hi:[1,1,0]
    v_pk_fma_f32 v[154:155], v[154:155], v[146:147], 2.0 op_sel_hi:[1,1,0]
    v_pk_fma_f32 v[156:157], v[156:157], v[148:149], 2.0 op_sel_hi:[1,1,0]
    s_add_u32 m0, s52, 90112
    s_add_u32 s45, s38, 49152
    buffer_load_dwordx4 v242, s[24:27], s45 offen lds
    v_pk_fma_f32 v[158:159], v[158:159], v[150:151], 2.0 op_sel_hi:[1,1,0]
    v_rcp_f32 v152, v152
    v_rcp_f32 v153, v153
    v_rcp_f32 v154, v154
    v_rcp_f32 v155, v155
    v_rcp_f32 v156, v156
    v_rcp_f32 v157, v157
    v_rcp_f32 v158, v158
    v_rcp_f32 v159, v159
    v_pk_fma_f32 v[152:153], v[152:153], v[232:233], v[236:237] op_sel_hi:[1,0,0]
    v_pk_fma_f32 v[154:155], v[154:155], v[232:233], v[236:237] op_sel_hi:[1,0,0]
    v_pk_fma_f32 v[156:157], v[156:157], v[232:233], v[236:237] op_sel_hi:[1,0,0]
    v_pk_fma_f32 v[158:159], v[158:159], v[232:233], v[236:237] op_sel_hi:[1,0,0]
    v_pk_mul_f32 v[152:153], v[152:153], v[36:37]
    v_pk_mul_f32 v[154:155], v[154:155], v[38:39]
    v_pk_mul_f32 v[156:157], v[156:157], v[40:41]
    v_pk_mul_f32 v[158:159], v[158:159], v[42:43]
    v_cvt_pk_bf16_f32 v128, v152, v153
    v_cvt_pk_bf16_f32 v129, v154, v155
    v_cvt_pk_bf16_f32 v130, v156, v157
    v_cvt_pk_bf16_f32 v131, v158, v159
    buffer_store_dwordx4 v[128:131], v240, s[28:31], s72 offen offset:3072 sc1
    ds_read_b64_tr_b16 v[52:53], v231 offset:0
    ds_read_b64_tr_b16 v[54:55], v231 offset:256
    ds_read_b64_tr_b16 v[56:57], v231 offset:512
    ds_read_b64_tr_b16 v[58:59], v231 offset:768
    ds_read_b64_tr_b16 v[60:61], v231 offset:1024
    ds_read_b64_tr_b16 v[62:63], v231 offset:1280
    ds_read_b64_tr_b16 v[64:65], v231 offset:1536
    ds_read_b64_tr_b16 v[66:67], v231 offset:1792
    v_mfma_f32_32x32x16_bf16 v[100:115], v[172:175], v[208:211], 0
    s_add_u32 m0, s52, 94208
    s_nop 0
    buffer_load_dwordx4 v242, s[24:27], s54 offen lds
    ds_read_b64_tr_b16 v[68:69], v231 offset:2048
    ds_read_b64_tr_b16 v[70:71], v231 offset:2304
    s_waitcnt lgkmcnt(8)
    v_mfma_f32_32x32x16_bf16 v[100:115], v[52:55], a[0:3], v[100:115]
    ds_read_b64_tr_b16 v[72:73], v231 offset:2560
    ds_read_b64_tr_b16 v[74:75], v231 offset:2816
    s_waitcnt lgkmcnt(8)
    v_mfma_f32_32x32x16_bf16 v[100:115], v[56:59], a[4:7], v[100:115]
    ds_read_b64_tr_b16 v[76:77], v231 offset:3072
    ds_read_b64_tr_b16 v[78:79], v231 offset:3328
    s_waitcnt lgkmcnt(8)
    v_mfma_f32_32x32x16_bf16 v[100:115], v[60:63], a[8:11], v[100:115]
    s_add_u32 m0, s52, 98304
    s_add_u32 s45, s54, 16384
    buffer_load_dwordx4 v242, s[24:27], s45 offen lds
    ds_read_b64_tr_b16 v[80:81], v231 offset:3584
    ds_read_b64_tr_b16 v[82:83], v231 offset:3840
    s_waitcnt lgkmcnt(8)
    v_mfma_f32_32x32x16_bf16 v[100:115], v[64:67], a[12:15], v[100:115]
    ds_read_b64_tr_b16 v[52:53], v231 offset:4096
    ds_read_b64_tr_b16 v[54:55], v231 offset:4352
    s_waitcnt lgkmcnt(8)
    v_mfma_f32_32x32x16_bf16 v[100:115], v[68:71], a[16:19], v[100:115]
    ds_read_b64_tr_b16 v[56:57], v231 offset:4608
    ds_read_b64_tr_b16 v[58:59], v231 offset:4864
    s_waitcnt lgkmcnt(8)
    v_mfma_f32_32x32x16_bf16 v[100:115], v[72:75], a[20:23], v[100:115]
    ds_read_b64_tr_b16 v[60:61], v231 offset:5120
    ds_read_b64_tr_b16 v[62:63], v231 offset:5376
    s_waitcnt lgkmcnt(8)
    v_mfma_f32_32x32x16_bf16 v[100:115], v[76:79], a[24:27], v[100:115]
    s_add_u32 m0, s52, 102400
    s_add_u32 s45, s54, 32768
    buffer_load_dwordx4 v242, s[24:27], s45 offen lds
    ds_read_b64_tr_b16 v[64:65], v231 offset:5632
    ds_read_b64_tr_b16 v[66:67], v231 offset:5888
    s_waitcnt lgkmcnt(8)
    v_mfma_f32_32x32x16_bf16 v[100:115], v[80:83], a[28:31], v[100:115]
    ds_read_b64_tr_b16 v[68:69], v231 offset:6144
    ds_read_b64_tr_b16 v[70:71], v231 offset:6400
    s_waitcnt lgkmcnt(8)
    v_mfma_f32_32x32x16_bf16 v[100:115], v[52:55], a[32:35], v[100:115]
    ds_read_b64_tr_b16 v[72:73], v231 offset:6656
    ds_read_b64_tr_b16 v[74:75], v231 offset:6912
    s_waitcnt lgkmcnt(8)
    v_mfma_f32_32x32x16_bf16 v[100:115], v[56:59], a[36:39], v[100:115]
    s_add_u32 m0, s52, 106496
    s_add_u32 s45, s54, 49152
    buffer_load_dwordx4 v242, s[24:27], s45 offen lds
    ds_read_b64_tr_b16 v[76:77], v231 offset:7168
    ds_read_b64_tr_b16 v[78:79], v231 offset:7424
    s_waitcnt lgkmcnt(8)
    v_mfma_f32_32x32x16_bf16 v[100:115], v[60:63], a[40:43], v[100:115]
    ds_read_b64_tr_b16 v[80:81], v231 offset:7680
    ds_read_b64_tr_b16 v[82:83], v231 offset:7936
    s_waitcnt lgkmcnt(8)
    v_mfma_f32_32x32x16_bf16 v[100:115], v[64:67], a[44:47], v[100:115]
    ds_read_b64_tr_b16 v[52:53], v231 offset:8192
    ds_read_b64_tr_b16 v[54:55], v231 offset:8448
    s_waitcnt lgkmcnt(8)
    v_mfma_f32_32x32x16_bf16 v[100:115], v[68:71], a[48:51], v[100:115]
    ds_read_b64_tr_b16 v[56:57], v231 offset:8704
    ds_read_b64_tr_b16 v[58:59], v231 offset:8960
    s_waitcnt lgkmcnt(8)
    v_mfma_f32_32x32x16_bf16 v[100:115], v[72:75], a[52:55], v[100:115]
    s_add_u32 m0, s52, 110592
    s_nop 0
    buffer_load_dwordx4 v242, s[24:27], s36 offen lds
    ds_read_b64_tr_b16 v[60:61], v231 offset:9216
    ds_read_b64_tr_b16 v[62:63], v231 offset:9472
    s_waitcnt lgkmcnt(8)
    v_mfma_f32_32x32x16_bf16 v[100:115], v[76:79], a[56:59], v[100:115]
    ds_read_b64_tr_b16 v[64:65], v231 offset:9728
    ds_read_b64_tr_b16 v[66:67], v231 offset:9984
    s_waitcnt lgkmcnt(8)
    v_mfma_f32_32x32x16_bf16 v[100:115], v[80:83], a[60:63], v[100:115]
    ds_read_b64_tr_b16 v[68:69], v231 offset:10240
    ds_read_b64_tr_b16 v[70:71], v231 offset:10496
    s_waitcnt lgkmcnt(8)
    v_mfma_f32_32x32x16_bf16 v[100:115], v[52:55], a[64:67], v[100:115]
    s_add_u32 m0, s52, 114688
    s_add_u32 s45, s36, 16384
    buffer_load_dwordx4 v242, s[24:27], s45 offen lds
    ds_read_b64_tr_b16 v[72:73], v231 offset:10752
    ds_read_b64_tr_b16 v[74:75], v231 offset:11008
    s_waitcnt lgkmcnt(8)
    v_mfma_f32_32x32x16_bf16 v[100:115], v[56:59], a[68:71], v[100:115]
    ds_read_b64_tr_b16 v[76:77], v231 offset:11264
    ds_read_b64_tr_b16 v[78:79], v231 offset:11520
    s_waitcnt lgkmcnt(8)
    v_mfma_f32_32x32x16_bf16 v[100:115], v[60:63], a[72:75], v[100:115]
    ds_read_b64_tr_b16 v[80:81], v231 offset:11776
    ds_read_b64_tr_b16 v[82:83], v231 offset:12032
    s_waitcnt lgkmcnt(8)
    v_mfma_f32_32x32x16_bf16 v[100:115], v[64:67], a[76:79], v[100:115]
    ds_read_b64_tr_b16 v[52:53], v231 offset:12288
    ds_read_b64_tr_b16 v[54:55], v231 offset:12544
    s_waitcnt lgkmcnt(8)
    v_mfma_f32_32x32x16_bf16 v[100:115], v[68:71], a[80:83], v[100:115]
    s_add_u32 m0, s52, 118784
    s_nop 0
    buffer_load_dwordx4 v242, s[24:27], s37 offen lds
    ds_read_b64_tr_b16 v[56:57], v231 offset:12800
    ds_read_b64_tr_b16 v[58:59], v231 offset:13056
    s_waitcnt lgkmcnt(8)
    v_mfma_f32_32x32x16_bf16 v[100:115], v[72:75], a[84:87], v[100:115]
    s_waitcnt vmcnt(7)
    s_add_u32 s45, s34, s49
    s_mov_b64 exec, 1
    s_cmp_eq_u32 s33, 0
    s_cbranch_scc1 L_wt_36
    buffer_store_dword v190, v191, s[28:31], s45 offen offset:1024
L_wb_37:
    s_mov_b64 exec, -1
    ds_read_b64_tr_b16 v[60:61], v231 offset:13312
    ds_read_b64_tr_b16 v[62:63], v231 offset:13568
    s_waitcnt lgkmcnt(8)
    v_mfma_f32_32x32x16_bf16 v[100:115], v[76:79], a[88:91], v[100:115]
    ds_read_b64_tr_b16 v[64:65], v231 offset:13824
    ds_read_b64_tr_b16 v[66:67], v231 offset:14080
    s_waitcnt lgkmcnt(8)
    v_mfma_f32_32x32x16_bf16 v[100:115], v[80:83], a[92:95], v[100:115]
    s_add_u32 m0, s52, 122880
    s_nop 0
    buffer_load_dwordx4 v242, s[24:27], s39 offen lds
    ds_read_b64_tr_b16 v[68:69], v231 offset:14336
    ds_read_b64_tr_b16 v[70:71], v231 offset:14592
    s_waitcnt lgkmcnt(8)
    v_mfma_f32_32x32x16_bf16 v[100:115], v[52:55], a[96:99], v[100:115]
    ds_read_b64_tr_b16 v[72:73], v231 offset:14848
    ds_read_b64_tr_b16 v[74:75], v231 offset:15104
    s_waitcnt lgkmcnt(8)
    v_mfma_f32_32x32x16_bf16 v[100:115], v[56:59], a[100:103], v[100:115]
    ds_read_b64_tr_b16 v[76:77], v231 offset:15360
    ds_read_b64_tr_b16 v[78:79], v231 offset:15616
    s_waitcnt lgkmcnt(8)
    v_mfma_f32_32x32x16_bf16 v[100:115], v[60:63], a[104:107], v[100:115]
    ds_read_b64_tr_b16 v[80:81], v231 offset:15872
    ds_read_b64_tr_b16 v[82:83], v231 offset:16128
    s_waitcnt lgkmcnt(8)
    v_mfma_f32_32x32x16_bf16 v[100:115], v[64:67], a[108:111], v[100:115]
    s_add_u32 m0, s52, 126976
    s_add_u32 s45, s39, 16384
    buffer_load_dwordx4 v242, s[24:27], s45 offen lds
    s_waitcnt lgkmcnt(6)
    v_mfma_f32_32x32x16_bf16 v[100:115], v[68:71], a[112:115], v[100:115]
    s_waitcnt lgkmcnt(4)
    v_mfma_f32_32x32x16_bf16 v[100:115], v[72:75], a[116:119], v[100:115]
    s_waitcnt lgkmcnt(2)
    v_mfma_f32_32x32x16_bf16 v[100:115], v[76:79], a[120:123], v[100:115]
    s_waitcnt lgkmcnt(0)
    v_mfma_f32_32x32x16_bf16 v[100:115], v[80:83], a[124:127], v[100:115]
    s_add_u32 m0, s52, 131072
    s_nop 0
    buffer_load_dwordx4 v242, s[24:27], s40 offen lds
    v_mfma_f32_32x32x16_bf16 v[84:99], v[184:187], v[208:211], 0
    s_nop 7
    v_mul_f32 v144, v100, v234
    v_mul_f32 v145, v101, v234
    v_exp_f32 v144, v144
    v_mul_f32 v146, v102, v234
    v_mfma_f32_32x32x16_bf16 v[84:99], a[128:131], a[0:3], v[84:99]
    v_exp_f32 v145, v145
    v_add_f32 v152, 2.0, v144
    v_mul_f32 v147, v103, v234
    v_exp_f32 v146, v146
    v_mfma_f32_32x32x16_bf16 v[84:99], a[132:135], a[4:7], v[84:99]
    v_add_f32 v153, 2.0, v145
    v_fma_f32 v152, v152, v144, 2.0
    v_mul_f32 v148, v104, v234
    v_exp_f32 v147, v147
    v_mfma_f32_32x32x16_bf16 v[84:99], a[136:139], a[8:11], v[84:99]
    v_add_f32 v154, 2.0, v146
    v_fma_f32 v153, v153, v145, 2.0
    v_rcp_f32 v152, v152
    s_add_u32 m0, s52, 135168
    s_nop 0
    buffer_load_dwordx4 v242, s[24:27], s59 offen lds
    v_mfma_f32_32x32x16_bf16 v[84:99], a[140:143], a[12:15], v[84:99]
    buffer_load_dword v189, v243, s[28:31], s49 offen offset:1024 sc1
    v_mul_f32 v149, v105, v234
    v_exp_f32 v148, v148
    v_add_f32 v155, 2.0, v147
    v_fma_f32 v154, v154, v146, 2.0
    v_mfma_f32_32x32x16_bf16 v[84:99], a[144:147], a[16:19], v[84:99]
    v_rcp_f32 v153, v153
    v_fma_f32 v152, v152, v232, v236
    v_mul_f32 v150, v106, v234
    v_exp_f32 v149, v149
    v_mfma_f32_32x32x16_bf16 v[84:99], a[148:151], a[20:23], v[84:99]
    v_add_f32 v156, 2.0, v148
    v_fma_f32 v155, v155, v147, 2.0
    v_rcp_f32 v154, v154
    s_add_u32 m0, s52, 139264
    s_add_u32 s45, s59, 16384
    buffer_load_dwordx4 v242, s[24:27], s45 offen lds
    v_mfma_f32_32x32x16_bf16 v[84:99], a[152:155], a[24:27], v[84:99]
    v_fma_f32 v153, v153, v232, v236
    v_mul_f32 v152, v152, v100
    v_mul_f32 v151, v107, v234
    v_exp_f32 v150, v150
    v_mfma_f32_32x32x16_bf16 v[84:99], a[156:159], a[28:31], v[84:99]
    v_add_f32 v157, 2.0, v149
    v_fma_f32 v156, v156, v148, 2.0
    v_rcp_f32 v155, v155
    v_fma_f32 v154, v154, v232, v236
    v_mfma_f32_32x32x16_bf16 v[84:99], a[160:163], a[32:35], v[84:99]
    v_mul_f32 v153, v153, v101
    v_exp_f32 v151, v151
    v_add_f32 v158, 2.0, v150
    v_fma_f32 v157, v157, v149, 2.0
    v_mfma_f32_32x32x16_bf16 v[84:99], a[164:167], a[36:39], v[84:99]
    v_rcp_f32 v156, v156
    v_fma_f32 v155, v155, v232, v236
    v_mul_f32 v154, v154, v102
    v_add_f32 v159, 2.0, v151
    s_add_u32 m0, s52, 143360
    s_nop 0
    buffer_load_dwordx4 v242, s[24:27], s71 offen lds
    v_mfma_f32_32x32x16_bf16 v[84:99], a[168:171], a[40:43], v[84:99]
    v_fma_f32 v158, v158, v150, 2.0
    v_rcp_f32 v157, v157
    v_fma_f32 v156, v156, v232, v236
    v_mul_f32 v155, v155, v103
    v_mfma_f32_32x32x16_bf16 v[84:99], a[172:175], a[44:47], v[84:99]
    v_fma_f32 v159, v159, v151, 2.0
    v_rcp_f32 v158, v158
    v_fma_f32 v157, v157, v232, v236
    v_mul_f32 v156, v156, v104
    v_mfma_f32_32x32x16_bf16 v[84:99], a[176:179], a[48:51], v[84:99]
    v_rcp_f32 v159, v159
    v_fma_f32 v158, v158, v232, v236
    v_mul_f32 v157, v157, v105
    v_fma_f32 v159, v159, v232, v236
    v_mfma_f32_32x32x16_bf16 v[84:99], a[180:183], a[52:55], v[84:99]
    s_waitcnt vmcnt(2)
    v_cmp_ne_u32 vcc, s47, v189
    s_cbranch_vccnz L_slow_38
L_back_40:
    v_mul_f32 v158, v158, v106
    v_mul_f32 v159, v159, v107
    v_cvt_pk_bf16_f32 v140, v152, v153
    v_cvt_pk_bf16_f32 v141, v154, v155
    v_cvt_pk_bf16_f32 v142, v156, v157
    v_mfma_f32_32x32x16_bf16 v[84:99], a[184:187], a[56:59], v[84:99]
    buffer_load_dwordx4 a[128:131], v240, s[28:31], s73 offen offset:0 sc1
    v_cvt_pk_bf16_f32 v143, v158, v159
    s_add_u32 s72, s72, 4096
    buffer_store_dwordx4 v[140:143], v240, s[28:31], s72 offen offset:2048 sc1
    v_lshl_add_u32 v248, v250, 2, v239
    v_lshlrev_b32 v248, 8, v248
    v_mfma_f32_32x32x16_bf16 v[84:99], a[188:191], a[60:63], v[84:99]
    buffer_load_dwordx4 a[132:135], v240, s[28:31], s73 offen offset:1024 sc1
    v_lshl_add_u32 v249, v244, 2, v245
    v_lshl_add_u32 v248, v249, 3, v248
    v_xor_b32 v249, 0, v239
    v_lshl_add_u32 v224, v249, 6, v248
    v_add_u32 v220, 0x10000, v224
    v_mfma_f32_32x32x16_bf16 v[84:99], a[192:195], a[64:67], v[84:99]
    buffer_load_dwordx4 a[136:139], v240, s[28:31], s73 offen offset:2048 sc1
    v_add_u32 v216, 0x20000, v224
    v_xor_b32 v249, 1, v239
    v_lshl_add_u32 v225, v249, 6, v248
    v_add_u32 v221, 0x10000, v225
    v_add_u32 v217, 0x20000, v225
    v_mfma_f32_32x32x16_bf16 v[84:99], a[196:199], a[68:71], v[84:99]
    buffer_load_dwordx4 a[140:143], v240, s[28:31], s73 offen offset:3072 sc1
    v_xor_b32 v249, 2, v239
    v_lshl_add_u32 v226, v249, 6, v248
    v_add_u32 v222, 0x10000, v226
    v_add_u32 v218, 0x20000, v226
    v_xor_b32 v249, 3, v239
    v_mfma_f32_32x32x16_bf16 v[84:99], a[200:203], a[72:75], v[84:99]
    buffer_load_dwordx4 a[144:147], v240, s[28:31], s74 offen offset:0 sc1
    v_lshl_add_u32 v227, v249, 6, v248
    v_add_u32 v223, 0x10000, v227
    v_add_u32 v219, 0x20000, v227
    s_add_u32 s43, s48, 720896
    s_mul_i32 s42, s3, 2048
    v_mfma_f32_32x32x16_bf16 v[84:99], a[204:207], a[76:79], v[84:99]
    buffer_load_dwordx4 a[148:151], v240, s[28:31], s74 offen offset:1024 sc1
    s_add_u32 s43, s43, s42
    s_add_u32 s41, s55, 0
    s_and_b32 s41, s41, 3
    s_lshl2_add_u32 s41, s56, s41
    s_mul_i32 s41, s41, 24576
    v_mfma_f32_32x32x16_bf16 v[84:99], a[208:211], a[80:83], v[84:99]
    buffer_load_dwordx4 a[152:155], v240, s[28:31], s74 offen offset:2048 sc1
    s_add_u32 s12, s41, s43
    s_add_u32 s41, s55, 1
    s_and_b32 s41, s41, 3
    s_lshl2_add_u32 s41, s56, s41
    s_mul_i32 s41, s41, 24576
    v_mfma_f32_32x32x16_bf16 v[84:99], a[212:215], a[84:87], v[84:99]
    buffer_load_dwordx4 a[156:159], v240, s[28:31], s74 offen offset:3072 sc1
    s_add_u32 s13, s41, s43
    s_add_u32 s41, s55, 2
    s_and_b32 s41, s41, 3
    s_lshl2_add_u32 s41, s56, s41
    s_mul_i32 s41, s41, 24576
    v_mfma_f32_32x32x16_bf16 v[84:99], a[216:219], a[88:91], v[84:99]
    buffer_load_dwordx4 a[160:163], v240, s[28:31], s75 offen offset:0 sc1
    s_add_u32 s14, s41, s43
    s_add_u32 s14, s14, 8192
    s_add_u32 s41, s55, 3
    s_and_b32 s41, s41, 3
    s_lshl2_add_u32 s41, s56, s41
    v_mfma_f32_32x32x16_bf16 v[84:99], a[220:223], a[92:95], v[84:99]
    buffer_load_dwordx4 a[164:167], v240, s[28:31], s75 offen offset:1024 sc1
    s_mul_i32 s41, s41, 24576
    s_add_u32 s15, s41, s43
    s_add_u32 s15, s15, 16384
    s_lshl2_add_u32 s41, s56, s55
    s_lshl_b32 s42, s41, 6
    v_mfma_f32_32x32x16_bf16 v[84:99], a[224:227], a[96:99], v[84:99]
    buffer_load_dwordx4 a[168:171], v240, s[28:31], s75 offen offset:2048 sc1
    s_add_u32 s53, s42, s50
    s_add_u32 s64, s53, 16384
    s_lshl_b32 s41, s3, 5
    s_add_u32 s41, s41, s56
    v_lshlrev_b32 v247, 2, v245
    v_mfma_f32_32x32x16_bf16 v[84:99], a[228:231], a[100:103], v[84:99]
    buffer_load_dwordx4 a[172:175], v240, s[28:31], s75 offen offset:3072 sc1
    v_add_lshl_u32 v247, v247, s41, 2
    s_mul_i32 s41, s3, 2560
    s_add_u32 s41, s41, 16384
    v_mul_u32_u24 v241, 80, v251
    v_lshl_add_u32 v241, v250, 3, v241
    v_mfma_f32_32x32x16_bf16 v[84:99], a[232:235], a[104:107], v[84:99]
    v_add_u32 v241, s41, v241
    v_lshrrev_b32 v248, 2, v252
    v_mul_u32_u24 v238, 80, v248
    v_lshl_add_u32 v238, v245, 4, v238
    v_add_u32 v238, s41, v238
    v_mfma_f32_32x32x16_bf16 v[84:99], a[236:239], a[108:111], v[84:99]
    v_lshlrev_b32 v215, 10, v248
    v_lshl_add_u32 v215, v245, 4, v215
    v_mfma_f32_32x32x16_bf16 v[84:99], a[240:243], a[112:115], v[84:99]
    v_mfma_f32_32x32x16_bf16 v[84:99], a[244:247], a[116:119], v[84:99]
    v_mfma_f32_32x32x16_bf16 v[84:99], a[248:251], a[120:123], v[84:99]
    v_mfma_f32_32x32x16_bf16 v[84:99], a[252:255], a[124:127], v[84:99]
    v_and_b32 v214, 1, v251
    v_lshlrev_b32 v214, 4, v214
    v_mov_b32 v212, 0x3f80
    v_lshlrev_b32 v212, v214, v212
    v_lshrrev_b32 v213, 3, v251
    v_bfe_u32 v214, v251, 1, 1
    v_lshl_add_u32 v213, v213, 1, v214
    v_bfe_u32 v207, v251, 2, 1
    v_cmp_eq_u32 vcc, v207, v250
    s_nop 1
    v_cndmask_b32 v213, -1, v213, vcc
    v_cmp_eq_u32 s[60:61], 0, v213
    v_cmp_eq_u32 vcc, 1, v213
    s_nop 0
    v_cndmask_b32 v44, 0, v212, s[60:61]
    v_cndmask_b32 v45, 0, v212, vcc
    v_cmp_eq_u32 s[60:61], 2, v213
    v_cmp_eq_u32 vcc, 3, v213
    s_nop 0
    v_cndmask_b32 v46, 0, v212, s[60:61]
    v_cndmask_b32 v47, 0, v212, vcc
    v_cmp_eq_u32 s[60:61], 4, v213
    v_cmp_eq_u32 vcc, 5, v213
    s_nop 0
    v_cndmask_b32 v48, 0, v212, s[60:61]
    v_cndmask_b32 v49, 0, v212, vcc
    v_cmp_eq_u32 s[60:61], 6, v213
    v_cmp_eq_u32 vcc, 7, v213
    s_nop 0
    v_cndmask_b32 v50, 0, v212, s[60:61]
    v_cndmask_b32 v51, 0, v212, vcc
    v_pk_mul_f32 v[144:145], v[84:85], v[234:235] op_sel_hi:[1,0]
    v_pk_mul_f32 v[146:147], v[86:87], v[234:235] op_sel_hi:[1,0]
    v_pk_mul_f32 v[148:149], v[88:89], v[234:235] op_sel_hi:[1,0]
    v_pk_mul_f32 v[150:151], v[90:91], v[234:235] op_sel_hi:[1,0]
    v_exp_f32 v144, v144
    v_exp_f32 v145, v145
    v_exp_f32 v146, v146
    v_exp_f32 v147, v147
    v_exp_f32 v148, v148
    v_exp_f32 v149, v149
    v_exp_f32 v150, v150
    v_exp_f32 v151, v151
    v_pk_add_f32 v[152:153], v[144:145], 2.0 op_sel_hi:[1,0]
    v_pk_add_f32 v[154:155], v[146:147], 2.0 op_sel_hi:[1,0]
    v_pk_add_f32 v[156:157], v[148:149], 2.0 op_sel_hi:[1,0]
    v_pk_add_f32 v[158:159], v[150:151], 2.0 op_sel_hi:[1,0]
    v_pk_fma_f32 v[152:153], v[152:153], v[144:145], 2.0 op_sel_hi:[1,1,0]
    v_pk_fma_f32 v[154:155], v[154:155], v[146:147], 2.0 op_sel_hi:[1,1,0]
    v_pk_fma_f32 v[156:157], v[156:157], v[148:149], 2.0 op_sel_hi:[1,1,0]
    v_pk_fma_f32 v[158:159], v[158:159], v[150:151], 2.0 op_sel_hi:[1,1,0]
    v_rcp_f32 v152, v152
    v_rcp_f32 v153, v153
    v_rcp_f32 v154, v154
    v_rcp_f32 v155, v155
    v_rcp_f32 v156, v156
    v_rcp_f32 v157, v157
    v_rcp_f32 v158, v158
    v_rcp_f32 v159, v159
    v_pk_fma_f32 v[152:153], v[152:153], v[232:233], v[236:237] op_sel_hi:[1,0,0]
    v_pk_fma_f32 v[154:155], v[154:155], v[232:233], v[236:237] op_sel_hi:[1,0,0]
    v_pk_fma_f32 v[156:157], v[156:157], v[232:233], v[236:237] op_sel_hi:[1,0,0]
    v_pk_fma_f32 v[158:159], v[158:159], v[232:233], v[236:237] op_sel_hi:[1,0,0]
    v_pk_mul_f32 v[152:153], v[152:153], v[84:85]
    v_pk_mul_f32 v[154:155], v[154:155], v[86:87]
    v_pk_mul_f32 v[156:157], v[156:157], v[88:89]
    v_pk_mul_f32 v[158:159], v[158:159], v[90:91]
    v_cvt_pk_bf16_f32 v132, v152, v153
    v_cvt_pk_bf16_f32 v133, v154, v155
    v_cvt_pk_bf16_f32 v134, v156, v157
    v_cvt_pk_bf16_f32 v135, v158, v159
    buffer_store_dwordx4 v[132:135], v240, s[28:31], s72 offen offset:0 sc1
    v_pk_mul_f32 v[144:145], v[92:93], v[234:235] op_sel_hi:[1,0]
    v_pk_mul_f32 v[146:147], v[94:95], v[234:235] op_sel_hi:[1,0]
    v_pk_mul_f32 v[148:149], v[96:97], v[234:235] op_sel_hi:[1,0]
    v_pk_mul_f32 v[150:151], v[98:99], v[234:235] op_sel_hi:[1,0]
    v_exp_f32 v144, v144
    v_exp_f32 v145, v145
    v_exp_f32 v146, v146
    v_exp_f32 v147, v147
    v_exp_f32 v148, v148
    v_exp_f32 v149, v149
    v_exp_f32 v150, v150
    v_exp_f32 v151, v151
    v_pk_add_f32 v[152:153], v[144:145], 2.0 op_sel_hi:[1,0]
    v_pk_add_f32 v[154:155], v[146:147], 2.0 op_sel_hi:[1,0]
    v_pk_add_f32 v[156:157], v[148:149], 2.0 op_sel_hi:[1,0]
    v_pk_add_f32 v[158:159], v[150:151], 2.0 op_sel_hi:[1,0]
    v_pk_fma_f32 v[152:153], v[152:153], v[144:145], 2.0 op_sel_hi:[1,1,0]
    v_pk_fma_f32 v[154:155], v[154:155], v[146:147], 2.0 op_sel_hi:[1,1,0]
    v_pk_fma_f32 v[156:157], v[156:157], v[148:149], 2.0 op_sel_hi:[1,1,0]
    v_pk_fma_f32 v[158:159], v[158:159], v[150:151], 2.0 op_sel_hi:[1,1,0]
    v_rcp_f32 v152, v152
    v_rcp_f32 v153, v153
    v_rcp_f32 v154, v154
    v_rcp_f32 v155, v155
    v_rcp_f32 v156, v156
    v_rcp_f32 v157, v157
    v_rcp_f32 v158, v158
    v_rcp_f32 v159, v159
    v_pk_fma_f32 v[152:153], v[152:153], v[232:233], v[236:237] op_sel_hi:[1,0,0]
    v_pk_fma_f32 v[154:155], v[154:155], v[232:233], v[236:237] op_sel_hi:[1,0,0]
    v_pk_fma_f32 v[156:157], v[156:157], v[232:233], v[236:237] op_sel_hi:[1,0,0]
    v_pk_fma_f32 v[158:159], v[158:159], v[232:233], v[236:237] op_sel_hi:[1,0,0]
    v_pk_mul_f32 v[152:153], v[152:153], v[92:93]
    v_pk_mul_f32 v[154:155], v[154:155], v[94:95]
    v_pk_mul_f32 v[156:157], v[156:157], v[96:97]
    v_pk_mul_f32 v[158:159], v[158:159], v[98:99]
    v_cvt_pk_bf16_f32 v136, v152, v153
    v_cvt_pk_bf16_f32 v137, v154, v155
    v_cvt_pk_bf16_f32 v138, v156, v157
    v_cvt_pk_bf16_f32 v139, v158, v159
    buffer_store_dwordx4 v[136:139], v240, s[28:31], s72 offen offset:1024 sc1
    s_barrier
    ds_read_b64_tr_b16 v[52:53], v225 offset:32768
    ds_read_b64_tr_b16 v[54:55], v225 offset:34816
    ds_read_b64_tr_b16 v[56:57], v226 offset:32768
    ds_read_b64_tr_b16 v[58:59], v226 offset:34816
    ds_read_b64_tr_b16 v[60:61], v227 offset:32768
    ds_read_b64_tr_b16 v[62:63], v227 offset:34816
    ds_read_b64_tr_b16 v[64:65], v225 offset:36864
    ds_read_b64_tr_b16 v[66:67], v225 offset:38912
    ds_read_b64_tr_b16 v[68:69], v226 offset:36864
    ds_read_b64_tr_b16 v[70:71], v226 offset:38912
    s_waitcnt lgkmcnt(8)
    v_mfma_f32_32x32x16_bf16 v[28:43], v[52:55], v[116:119], 0
    ds_read_b64_tr_b16 v[72:73], v227 offset:36864
    ds_read_b64_tr_b16 v[74:75], v227 offset:38912
    s_waitcnt lgkmcnt(8)
    v_mfma_f32_32x32x16_bf16 v[84:99], v[56:59], v[116:119], 0
    ds_read_b64_tr_b16 v[76:77], v225 offset:40960
    ds_read_b64_tr_b16 v[78:79], v225 offset:43008
    s_waitcnt lgkmcnt(8)
    v_mfma_f32_32x32x16_bf16 v[100:115], v[60:63], v[116:119], 0
    ds_read_b64_tr_b16 v[80:81], v226 offset:40960
    ds_read_b64_tr_b16 v[82:83], v226 offset:43008
    s_waitcnt lgkmcnt(8)
    v_mfma_f32_32x32x16_bf16 v[28:43], v[64:67], v[120:123], v[28:43]
    ds_read_b64_tr_b16 v[52:53], v227 offset:40960
    ds_read_b64_tr_b16 v[54:55], v227 offset:43008
    s_waitcnt lgkmcnt(8)
    v_mfma_f32_32x32x16_bf16 v[84:99], v[68:71], v[120:123], v[84:99]
    ds_read_b64_tr_b16 v[56:57], v225 offset:45056
    ds_read_b64_tr_b16 v[58:59], v225 offset:47104
    s_waitcnt lgkmcnt(8)
    v_mfma_f32_32x32x16_bf16 v[100:115], v[72:75], v[120:123], v[100:115]
    ds_read_b64_tr_b16 v[60:61], v226 offset:45056
    ds_read_b64_tr_b16 v[62:63], v226 offset:47104
    s_waitcnt lgkmcnt(8)
    v_mfma_f32_32x32x16_bf16 v[28:43], v[76:79], v[124:127], v[28:43]
    ds_read_b64_tr_b16 v[64:65], v227 offset:45056
    ds_read_b64_tr_b16 v[66:67], v227 offset:47104
    s_waitcnt lgkmcnt(8)
    v_mfma_f32_32x32x16_bf16 v[84:99], v[80:83], v[124:127], v[84:99]
    ds_read_b64_tr_b16 v[68:69], v225 offset:49152
    ds_read_b64_tr_b16 v[70:71], v225 offset:51200
    s_waitcnt lgkmcnt(8)
    v_mfma_f32_32x32x16_bf16 v[100:115], v[52:55], v[124:127], v[100:115]
    ds_read_b64_tr_b16 v[72:73], v226 offset:49152
    ds_read_b64_tr_b16 v[74:75], v226 offset:51200
    s_waitcnt lgkmcnt(8)
    v_mfma_f32_32x32x16_bf16 v[28:43], v[56:59], v[128:131], v[28:43]
    ds_read_b64_tr_b16 v[76:77], v227 offset:49152
    ds_read_b64_tr_b16 v[78:79], v227 offset:51200
    s_waitcnt lgkmcnt(8)
    v_mfma_f32_32x32x16_bf16 v[84:99], v[60:63], v[128:131], v[84:99]
    ds_read_b64_tr_b16 v[80:81], v225 offset:53248
    ds_read_b64_tr_b16 v[82:83], v225 offset:55296
    s_waitcnt lgkmcnt(8)
    v_mfma_f32_32x32x16_bf16 v[100:115], v[64:67], v[128:131], v[100:115]
    ds_read_b64_tr_b16 v[52:53], v226 offset:53248
    ds_read_b64_tr_b16 v[54:55], v226 offset:55296
    s_waitcnt lgkmcnt(8)
    v_mfma_f32_32x32x16_bf16 v[28:43], v[68:71], v[132:135], v[28:43]
    ds_read_b64_tr_b16 v[56:57], v227 offset:53248
    ds_read_b64_tr_b16 v[58:59], v227 offset:55296
    s_waitcnt lgkmcnt(8)
    v_mfma_f32_32x32x16_bf16 v[84:99], v[72:75], v[132:135], v[84:99]
    ds_read_b64_tr_b16 v[60:61], v225 offset:57344
    ds_read_b64_tr_b16 v[62:63], v225 offset:59392
    s_waitcnt lgkmcnt(8)
    v_mfma_f32_32x32x16_bf16 v[100:115], v[76:79], v[132:135], v[100:115]
    ds_read_b64_tr_b16 v[64:65], v226 offset:57344
    ds_read_b64_tr_b16 v[66:67], v226 offset:59392
    s_waitcnt lgkmcnt(8)
    v_mfma_f32_32x32x16_bf16 v[28:43], v[80:83], v[136:139], v[28:43]
    ds_read_b64_tr_b16 v[68:69], v227 offset:57344
    ds_read_b64_tr_b16 v[70:71], v227 offset:59392
    s_waitcnt lgkmcnt(8)
    v_mfma_f32_32x32x16_bf16 v[84:99], v[52:55], v[136:139], v[84:99]
    s_barrier
    ds_read_b64_tr_b16 v[72:73], v225 offset:61440
    ds_read_b64_tr_b16 v[74:75], v225 offset:63488
    s_waitcnt lgkmcnt(8)
    v_mfma_f32_32x32x16_bf16 v[100:115], v[56:59], v[136:139], v[100:115]
    ds_read_b64_tr_b16 v[76:77], v226 offset:61440
    ds_read_b64_tr_b16 v[78:79], v226 offset:63488
    s_waitcnt lgkmcnt(8)
    v_mfma_f32_32x32x16_bf16 v[28:43], v[60:63], v[140:143], v[28:43]
    s_waitcnt vmcnt(0)
    s_add_u32 s45, s34, s49
    s_mov_b64 exec, 1
    s_cmp_eq_u32 s33, 0
    s_cbranch_scc1 L_wt_41
    buffer_store_dword v190, v191, s[28:31], s45 offen offset:1536
L_wb_42:
    s_mov_b64 exec, -1
    ds_read_b64_tr_b16 v[80:81], v227 offset:61440
    ds_read_b64_tr_b16 v[82:83], v227 offset:63488
    s_waitcnt lgkmcnt(8)
    v_mfma_f32_32x32x16_bf16 v[84:99], v[64:67], v[140:143], v[84:99]
    ds_read_b64_tr_b16 v[52:53], v221 offset:0
    ds_read_b64_tr_b16 v[54:55], v221 offset:2048
    s_waitcnt lgkmcnt(8)
    v_mfma_f32_32x32x16_bf16 v[100:115], v[68:71], v[140:143], v[100:115]
    ds_read_b64_tr_b16 v[56:57], v222 offset:0
    ds_read_b64_tr_b16 v[58:59], v222 offset:2048
    s_waitcnt lgkmcnt(8)
    v_mfma_f32_32x32x16_bf16 v[28:43], v[72:75], a[128:131], v[28:43]
    ds_read_b64_tr_b16 v[60:61], v223 offset:0
    ds_read_b64_tr_b16 v[62:63], v223 offset:2048
    s_waitcnt lgkmcnt(8)
    v_mfma_f32_32x32x16_bf16 v[84:99], v[76:79], a[128:131], v[84:99]
    ds_read_b64_tr_b16 v[64:65], v221 offset:4096
    ds_read_b64_tr_b16 v[66:67], v221 offset:6144
    s_waitcnt lgkmcnt(8)
    v_mfma_f32_32x32x16_bf16 v[100:115], v[80:83], a[128:131], v[100:115]
    ds_read_b64_tr_b16 v[68:69], v222 offset:4096
    ds_read_b64_tr_b16 v[70:71], v222 offset:6144
    s_waitcnt lgkmcnt(8)
    v_mfma_f32_32x32x16_bf16 v[28:43], v[52:55], a[132:135], v[28:43]
    ds_read_b64_tr_b16 v[72:73], v223 offset:4096
    ds_read_b64_tr_b16 v[74:75], v223 offset:6144
    s_waitcnt lgkmcnt(8)
    v_mfma_f32_32x32x16_bf16 v[84:99], v[56:59], a[132:135], v[84:99]
    ds_read_b64_tr_b16 v[76:77], v221 offset:8192
    ds_read_b64_tr_b16 v[78:79], v221 offset:10240
    s_waitcnt lgkmcnt(8)
    v_mfma_f32_32x32x16_bf16 v[100:115], v[60:63], a[132:135], v[100:115]
    ds_read_b64_tr_b16 v[80:81], v222 offset:8192
    ds_read_b64_tr_b16 v[82:83], v222 offset:10240
    s_waitcnt lgkmcnt(8)
    v_mfma_f32_32x32x16_bf16 v[28:43], v[64:67], a[136:139], v[28:43]
    ds_read_b64_tr_b16 v[52:53], v223 offset:8192
    ds_read_b64_tr_b16 v[54:55], v223 offset:10240
    s_waitcnt lgkmcnt(8)
    v_mfma_f32_32x32x16_bf16 v[84:99], v[68:71], a[136:139], v[84:99]
    ds_read_b64_tr_b16 v[56:57], v221 offset:12288
    ds_read_b64_tr_b16 v[58:59], v221 offset:14336
    s_waitcnt lgkmcnt(8)
    v_mfma_f32_32x32x16_bf16 v[100:115], v[72:75], a[136:139], v[100:115]
    ds_read_b64_tr_b16 v[60:61], v222 offset:12288
    ds_read_b64_tr_b16 v[62:63], v222 offset:14336
    s_waitcnt lgkmcnt(8)
    v_mfma_f32_32x32x16_bf16 v[28:43], v[76:79], a[140:143], v[28:43]
    buffer_load_dword v189, v243, s[28:31], s49 offen offset:1536 sc1
    ds_read_b64_tr_b16 v[64:65], v223 offset:12288
    ds_read_b64_tr_b16 v[66:67], v223 offset:14336
    s_waitcnt lgkmcnt(8)
    v_mfma_f32_32x32x16_bf16 v[84:99], v[80:83], a[140:143], v[84:99]
    ds_read_b64_tr_b16 v[68:69], v221 offset:16384
    ds_read_b64_tr_b16 v[70:71], v221 offset:18432
    s_waitcnt lgkmcnt(8)
    v_mfma_f32_32x32x16_bf16 v[100:115], v[52:55], a[140:143], v[100:115]
    ds_read_b64_tr_b16 v[72:73], v222 offset:16384
    ds_read_b64_tr_b16 v[74:75], v222 offset:18432
    s_waitcnt lgkmcnt(8)
    v_mfma_f32_32x32x16_bf16 v[28:43], v[56:59], a[144:147], v[28:43]
    ds_read_b64_tr_b16 v[76:77], v223 offset:16384
    ds_read_b64_tr_b16 v[78:79], v223 offset:18432
    s_waitcnt lgkmcnt(8)
    v_mfma_f32_32x32x16_bf16 v[84:99], v[60:63], a[144:147], v[84:99]
    ds_read_b64_tr_b16 v[80:81], v221 offset:20480
    ds_read_b64_tr_b16 v[82:83], v221 offset:22528
    s_waitcnt lgkmcnt(8)
    v_mfma_f32_32x32x16_bf16 v[100:115], v[64:67], a[144:147], v[100:115]
    ds_read_b64_tr_b16 v[52:53], v222 offset:20480
    ds_read_b64_tr_b16 v[54:55], v222 offset:22528
    s_waitcnt lgkmcnt(8)
    v_mfma_f32_32x32x16_bf16 v[28:43], v[68:71], a[148:151], v[28:43]
    ds_read_b64_tr_b16 v[56:57], v223 offset:20480
    ds_read_b64_tr_b16 v[58:59], v223 offset:22528
    s_waitcnt lgkmcnt(8)
    v_mfma_f32_32x32x16_bf16 v[84:99], v[72:75], a[148:151], v[84:99]
    ds_read_b64_tr_b16 v[60:61], v221 offset:24576
    ds_read_b64_tr_b16 v[62:63], v221 offset:26624
    s_waitcnt lgkmcnt(8)
    v_mfma_f32_32x32x16_bf16 v[100:115], v[76:79], a[148:151], v[100:115]
    s_waitcnt vmcnt(0)
    v_cmp_ne_u32 vcc, s47, v189
    s_cbranch_vccnz L_slow_43
L_back_45:
    ds_read_b64_tr_b16 v[64:65], v222 offset:24576
    ds_read_b64_tr_b16 v[66:67], v222 offset:26624
    s_waitcnt lgkmcnt(8)
    v_mfma_f32_32x32x16_bf16 v[28:43], v[80:83], a[152:155], v[28:43]
    s_add_u32 s73, s73, 4096
    buffer_load_dwordx4 a[176:179], v240, s[28:31], s73 offen offset:0 sc1
    ds_read_b64_tr_b16 v[68:69], v223 offset:24576
    ds_read_b64_tr_b16 v[70:71], v223 offset:26624
    s_waitcnt lgkmcnt(8)
    v_mfma_f32_32x32x16_bf16 v[84:99], v[52:55], a[152:155], v[84:99]
    buffer_load_dwordx4 a[180:183], v240, s[28:31], s73 offen offset:1024 sc1
    ds_read_b64_tr_b16 v[72:73], v221 offset:28672
    ds_read_b64_tr_b16 v[74:75], v221 offset:30720
    s_waitcnt lgkmcnt(8)
    v_mfma_f32_32x32x16_bf16 v[100:115], v[56:59], a[152:155], v[100:115]
    buffer_load_dwordx4 a[184:187], v240, s[28:31], s73 offen offset:2048 sc1
    ds_read_b64_tr_b16 v[76:77], v222 offset:28672
    ds_read_b64_tr_b16 v[78:79], v222 offset:30720
    s_waitcnt lgkmcnt(8)
    v_mfma_f32_32x32x16_bf16 v[28:43], v[60:63], a[156:159], v[28:43]
    s_add_u32 s74, s74, 4096
    buffer_load_dwordx4 a[188:191], v240, s[28:31], s74 offen offset:0 sc1
    ds_read_b64_tr_b16 v[80:81], v223 offset:28672
    ds_read_b64_tr_b16 v[82:83], v223 offset:30720
    s_waitcnt lgkmcnt(8)
    v_mfma_f32_32x32x16_bf16 v[84:99], v[64:67], a[156:159], v[84:99]
    buffer_load_dwordx4 a[192:195], v240, s[28:31], s74 offen offset:1024 sc1
    ds_read_b64_tr_b16 v[52:53], v221 offset:32768
    ds_read_b64_tr_b16 v[54:55], v221 offset:34816
    s_waitcnt lgkmcnt(8)
    v_mfma_f32_32x32x16_bf16 v[100:115], v[68:71], a[156:159], v[100:115]
    buffer_load_dwordx4 a[196:199], v240, s[28:31], s74 offen offset:2048 sc1
    ds_read_b64_tr_b16 v[56:57], v222 offset:32768
    ds_read_b64_tr_b16 v[58:59], v222 offset:34816
    s_waitcnt lgkmcnt(8)
    v_mfma_f32_32x32x16_bf16 v[28:43], v[72:75], a[160:163], v[28:43]
    s_add_u32 s75, s75, 4096
    buffer_load_dwordx4 a[200:203], v240, s[28:31], s75 offen offset:0 sc1
    ds_read_b64_tr_b16 v[60:61], v223 offset:32768
    ds_read_b64_tr_b16 v[62:63], v223 offset:34816
    s_waitcnt lgkmcnt(8)
    v_mfma_f32_32x32x16_bf16 v[84:99], v[76:79], a[160:163], v[84:99]
    buffer_load_dwordx4 a[204:207], v240, s[28:31], s75 offen offset:1024 sc1
    ds_read_b64_tr_b16 v[64:65], v221 offset:36864
    ds_read_b64_tr_b16 v[66:67], v221 offset:38912
    s_waitcnt lgkmcnt(8)
    v_mfma_f32_32x32x16_bf16 v[100:115], v[80:83], a[160:163], v[100:115]
    buffer_load_dwordx4 a[208:211], v240, s[28:31], s75 offen offset:2048 sc1
    ds_read_b64_tr_b16 v[68:69], v222 offset:36864
    ds_read_b64_tr_b16 v[70:71], v222 offset:38912
    s_waitcnt lgkmcnt(8)
    v_mfma_f32_32x32x16_bf16 v[28:43], v[52:55], a[164:167], v[28:43]
    ds_read_b64_tr_b16 v[72:73], v223 offset:36864
    ds_read_b64_tr_b16 v[74:75], v223 offset:38912
    s_waitcnt lgkmcnt(8)
    v_mfma_f32_32x32x16_bf16 v[84:99], v[56:59], a[164:167], v[84:99]
    ds_read_b64_tr_b16 v[76:77], v221 offset:40960
    ds_read_b64_tr_b16 v[78:79], v221 offset:43008
    s_waitcnt lgkmcnt(8)
    v_mfma_f32_32x32x16_bf16 v[100:115], v[60:63], a[164:167], v[100:115]
    ds_read_b64_tr_b16 v[80:81], v222 offset:40960
    ds_read_b64_tr_b16 v[82:83], v222 offset:43008
    s_waitcnt lgkmcnt(8)
    v_mfma_f32_32x32x16_bf16 v[28:43], v[64:67], a[168:171], v[28:43]
    ds_read_b64_tr_b16 v[52:53], v223 offset:40960
    ds_read_b64_tr_b16 v[54:55], v223 offset:43008
    s_waitcnt lgkmcnt(8)
    v_mfma_f32_32x32x16_bf16 v[84:99], v[68:71], a[168:171], v[84:99]
    s_barrier
    ds_read_b64_tr_b16 v[56:57], v221 offset:45056
    ds_read_b64_tr_b16 v[58:59], v221 offset:47104
    s_waitcnt lgkmcnt(8)
    v_mfma_f32_32x32x16_bf16 v[100:115], v[72:75], a[168:171], v[100:115]
    ds_read_b64_tr_b16 v[60:61], v221 offset:49152
    ds_read_b64_tr_b16 v[62:63], v221 offset:51200
    s_waitcnt lgkmcnt(8)
    v_mfma_f32_32x32x16_bf16 v[28:43], v[76:79], a[172:175], v[28:43]
    ds_read_b64_tr_b16 v[64:65], v221 offset:53248
    ds_read_b64_tr_b16 v[66:67], v221 offset:55296
    s_waitcnt lgkmcnt(8)
    v_mfma_f32_32x32x16_bf16 v[84:99], v[80:83], a[172:175], v[84:99]
    ds_read_b64_tr_b16 v[68:69], v221 offset:57344
    ds_read_b64_tr_b16 v[70:71], v221 offset:59392
    s_waitcnt lgkmcnt(8)
    v_mfma_f32_32x32x16_bf16 v[100:115], v[52:55], a[172:175], v[100:115]
    ds_read_b64_tr_b16 v[72:73], v221 offset:61440
    ds_read_b64_tr_b16 v[74:75], v221 offset:63488
    s_waitcnt vmcnt(8) lgkmcnt(8)
    v_mfma_f32_32x32x16_bf16 v[28:43], v[56:59], a[176:179], v[28:43]
    ds_read_b64_tr_b16 v[76:77], v217 offset:0
    ds_read_b64_tr_b16 v[78:79], v217 offset:2048
    s_waitcnt vmcnt(7) lgkmcnt(8)
    v_mfma_f32_32x32x16_bf16 v[28:43], v[60:63], a[180:183], v[28:43]
    ds_read_b64_tr_b16 v[80:81], v217 offset:4096
    ds_read_b64_tr_b16 v[82:83], v217 offset:6144
    s_waitcnt vmcnt(6) lgkmcnt(8)
    v_mfma_f32_32x32x16_bf16 v[28:43], v[64:67], a[184:187], v[28:43]
    ds_read_b64_tr_b16 v[52:53], v217 offset:8192
    ds_read_b64_tr_b16 v[54:55], v217 offset:10240
    s_waitcnt vmcnt(5) lgkmcnt(8)
    v_mfma_f32_32x32x16_bf16 v[28:43], v[68:71], a[188:191], v[28:43]
    ds_read_b64_tr_b16 v[56:57], v217 offset:12288
    ds_read_b64_tr_b16 v[58:59], v217 offset:14336
    s_waitcnt vmcnt(4) lgkmcnt(8)
    v_mfma_f32_32x32x16_bf16 v[28:43], v[72:75], a[192:195], v[28:43]
    ds_read_b64_tr_b16 v[60:61], v222 offset:45056
    ds_read_b64_tr_b16 v[62:63], v222 offset:47104
    s_waitcnt vmcnt(3) lgkmcnt(8)
    v_mfma_f32_32x32x16_bf16 v[28:43], v[76:79], a[196:199], v[28:43]
    ds_read_b64_tr_b16 v[64:65], v222 offset:49152
    ds_read_b64_tr_b16 v[66:67], v222 offset:51200
    s_waitcnt vmcnt(2) lgkmcnt(8)
    v_mfma_f32_32x32x16_bf16 v[28:43], v[80:83], a[200:203], v[28:43]
    ds_read_b64_tr_b16 v[68:69], v222 offset:53248
    ds_read_b64_tr_b16 v[70:71], v222 offset:55296
    s_waitcnt vmcnt(1) lgkmcnt(8)
    v_mfma_f32_32x32x16_bf16 v[28:43], v[52:55], a[204:207], v[28:43]
    ds_read_b64_tr_b16 v[72:73], v222 offset:57344
    ds_read_b64_tr_b16 v[74:75], v222 offset:59392
    s_waitcnt vmcnt(0) lgkmcnt(8)
    v_mfma_f32_32x32x16_bf16 v[28:43], v[56:59], a[208:211], v[28:43]
    ds_read_b64_tr_b16 v[76:77], v222 offset:61440
    ds_read_b64_tr_b16 v[78:79], v222 offset:63488
    s_waitcnt lgkmcnt(8)
    v_mfma_f32_32x32x16_bf16 v[84:99], v[60:63], a[176:179], v[84:99]
    ds_read_b64_tr_b16 v[80:81], v218 offset:0
    ds_read_b64_tr_b16 v[82:83], v218 offset:2048
    s_waitcnt lgkmcnt(8)
    v_mfma_f32_32x32x16_bf16 v[84:99], v[64:67], a[180:183], v[84:99]
    s_nop 3
    v_cvt_pk_bf16_f32 v144, v28, v29
    v_cvt_pk_bf16_f32 v145, v30, v31
    ds_read_b64_tr_b16 v[52:53], v218 offset:4096
    ds_read_b64_tr_b16 v[54:55], v218 offset:6144
    s_waitcnt lgkmcnt(8)
    v_mfma_f32_32x32x16_bf16 v[84:99], v[68:71], a[184:187], v[84:99]
    v_cvt_pk_bf16_f32 v146, v32, v33
    v_cvt_pk_bf16_f32 v147, v34, v35
    buffer_store_dwordx4 v[144:147], v240, s[28:31], s13 offen offset:0 sc1
    ds_read_b64_tr_b16 v[56:57], v218 offset:8192
    ds_read_b64_tr_b16 v[58:59], v218 offset:10240
    s_waitcnt lgkmcnt(8)
    v_mfma_f32_32x32x16_bf16 v[84:99], v[72:75], a[188:191], v[84:99]
    v_cvt_pk_bf16_f32 v148, v36, v37
    v_cvt_pk_bf16_f32 v149, v38, v39
    ds_read_b64_tr_b16 v[60:61], v218 offset:12288
    ds_read_b64_tr_b16 v[62:63], v218 offset:14336
    s_waitcnt lgkmcnt(8)
    v_mfma_f32_32x32x16_bf16 v[84:99], v[76:79], a[192:195], v[84:99]
    v_cvt_pk_bf16_f32 v150, v40, v41
    v_cvt_pk_bf16_f32 v151, v42, v43
    buffer_store_dwordx4 v[148:151], v240, s[28:31], s13 offen offset:1024 sc1
    ds_read_b64_tr_b16 v[64:65], v223 offset:45056
    ds_read_b64_tr_b16 v[66:67], v223 offset:47104
    s_waitcnt lgkmcnt(8)
    v_mfma_f32_32x32x16_bf16 v[84:99], v[80:83], a[196:199], v[84:99]
    ds_read_b64_tr_b16 v[68:69], v223 offset:49152
    ds_read_b64_tr_b16 v[70:71], v223 offset:51200
    s_waitcnt lgkmcnt(8)
    v_mfma_f32_32x32x16_bf16 v[84:99], v[52:55], a[200:203], v[84:99]
    ds_read_b64_tr_b16 v[72:73], v223 offset:53248
    ds_read_b64_tr_b16 v[74:75], v223 offset:55296
    s_waitcnt lgkmcnt(8)
    v_mfma_f32_32x32x16_bf16 v[84:99], v[56:59], a[204:207], v[84:99]
    ds_read_b64_tr_b16 v[76:77], v223 offset:57344
    ds_read_b64_tr_b16 v[78:79], v223 offset:59392
    s_waitcnt lgkmcnt(8)
    v_mfma_f32_32x32x16_bf16 v[84:99], v[60:63], a[208:211], v[84:99]
    ds_read_b64_tr_b16 v[80:81], v223 offset:61440
    ds_read_b64_tr_b16 v[82:83], v223 offset:63488
    s_waitcnt lgkmcnt(8)
    v_mfma_f32_32x32x16_bf16 v[100:115], v[64:67], a[176:179], v[100:115]
    ds_read_b64_tr_b16 v[52:53], v219 offset:0
    ds_read_b64_tr_b16 v[54:55], v219 offset:2048
    s_waitcnt lgkmcnt(8)
    v_mfma_f32_32x32x16_bf16 v[100:115], v[68:71], a[180:183], v[100:115]
    s_nop 3
    v_cvt_pk_bf16_f32 v152, v84, v85
    v_cvt_pk_bf16_f32 v153, v86, v87
    ds_read_b64_tr_b16 v[56:57], v219 offset:4096
    ds_read_b64_tr_b16 v[58:59], v219 offset:6144
    s_waitcnt lgkmcnt(8)
    v_mfma_f32_32x32x16_bf16 v[100:115], v[72:75], a[184:187], v[100:115]
    v_cvt_pk_bf16_f32 v154, v88, v89
    v_cvt_pk_bf16_f32 v155, v90, v91
    buffer_store_dwordx4 v[152:155], v240, s[28:31], s14 offen offset:0 sc1
    ds_read_b64_tr_b16 v[60:61], v219 offset:8192
    ds_read_b64_tr_b16 v[62:63], v219 offset:10240
    s_waitcnt lgkmcnt(8)
    v_mfma_f32_32x32x16_bf16 v[100:115], v[76:79], a[188:191], v[100:115]
    v_cvt_pk_bf16_f32 v156, v92, v93
    v_cvt_pk_bf16_f32 v157, v94, v95
    ds_read_b64_tr_b16 v[64:65], v219 offset:12288
    ds_read_b64_tr_b16 v[66:67], v219 offset:14336
    s_waitcnt lgkmcnt(8)
    v_mfma_f32_32x32x16_bf16 v[100:115], v[80:83], a[192:195], v[100:115]
    v_cvt_pk_bf16_f32 v158, v96, v97
    v_cvt_pk_bf16_f32 v159, v98, v99
    buffer_store_dwordx4 v[156:159], v240, s[28:31], s14 offen offset:1024 sc1
    ds_read_b64_tr_b16 v[68:69], v224 offset:32768
    ds_read_b64_tr_b16 v[70:71], v224 offset:34816
    s_waitcnt lgkmcnt(8)
    v_mfma_f32_32x32x16_bf16 v[100:115], v[52:55], a[196:199], v[100:115]
    ds_read_b64_tr_b16 v[72:73], v224 offset:36864
    ds_read_b64_tr_b16 v[74:75], v224 offset:38912
    s_waitcnt lgkmcnt(8)
    v_mfma_f32_32x32x16_bf16 v[100:115], v[56:59], a[200:203], v[100:115]
    ds_read_b64_tr_b16 v[76:77], v224 offset:40960
    ds_read_b64_tr_b16 v[78:79], v224 offset:43008
    s_waitcnt lgkmcnt(8)
    v_mfma_f32_32x32x16_bf16 v[100:115], v[60:63], a[204:207], v[100:115]
    ds_read_b64_tr_b16 v[80:81], v224 offset:45056
    ds_read_b64_tr_b16 v[82:83], v224 offset:47104
    s_waitcnt lgkmcnt(8)
    v_mfma_f32_32x32x16_bf16 v[100:115], v[64:67], a[208:211], v[100:115]
    ds_read_b64_tr_b16 v[52:53], v224 offset:49152
    ds_read_b64_tr_b16 v[54:55], v224 offset:51200
    s_waitcnt lgkmcnt(8)
    v_mfma_f32_32x32x16_bf16 v[4:19], v[68:71], v[116:119], 0
    ds_read_b64_tr_b16 v[56:57], v224 offset:53248
    ds_read_b64_tr_b16 v[58:59], v224 offset:55296
    s_waitcnt lgkmcnt(8)
    v_mfma_f32_32x32x16_bf16 v[4:19], v[72:75], v[120:123], v[4:19]
    s_nop 3
    v_cvt_pk_bf16_f32 v160, v100, v101
    v_cvt_pk_bf16_f32 v161, v102, v103
    ds_read_b64_tr_b16 v[60:61], v224 offset:57344
    ds_read_b64_tr_b16 v[62:63], v224 offset:59392
    s_waitcnt lgkmcnt(8)
    v_mfma_f32_32x32x16_bf16 v[4:19], v[76:79], v[124:127], v[4:19]
    v_cvt_pk_bf16_f32 v162, v104, v105
    v_cvt_pk_bf16_f32 v163, v106, v107
    buffer_store_dwordx4 v[160:163], v240, s[28:31], s15 offen offset:0 sc1
    ds_read_b64_tr_b16 v[64:65], v224 offset:61440
    ds_read_b64_tr_b16 v[66:67], v224 offset:63488
    s_waitcnt lgkmcnt(8)
    v_mfma_f32_32x32x16_bf16 v[4:19], v[80:83], v[128:131], v[4:19]
    v_cvt_pk_bf16_f32 v164, v108, v109
    v_cvt_pk_bf16_f32 v165, v110, v111
    ds_read_b64_tr_b16 v[68:69], v220 offset:0
    ds_read_b64_tr_b16 v[70:71], v220 offset:2048
    s_waitcnt lgkmcnt(8)
    v_mfma_f32_32x32x16_bf16 v[4:19], v[52:55], v[132:135], v[4:19]
    v_cvt_pk_bf16_f32 v166, v112, v113
    v_cvt_pk_bf16_f32 v167, v114, v115
    buffer_store_dwordx4 v[164:167], v240, s[28:31], s15 offen offset:1024 sc1
    ds_read_b64_tr_b16 v[72:73], v220 offset:4096
    ds_read_b64_tr_b16 v[74:75], v220 offset:6144
    s_waitcnt lgkmcnt(8)
    v_mfma_f32_32x32x16_bf16 v[4:19], v[56:59], v[136:139], v[4:19]
    ds_read_b64_tr_b16 v[76:77], v220 offset:8192
    ds_read_b64_tr_b16 v[78:79], v220 offset:10240
    s_waitcnt lgkmcnt(8)
    v_mfma_f32_32x32x16_bf16 v[4:19], v[60:63], v[140:143], v[4:19]
    ds_read_b64_tr_b16 v[80:81], v220 offset:12288
    ds_read_b64_tr_b16 v[82:83], v220 offset:14336
    s_waitcnt lgkmcnt(8)
    v_mfma_f32_32x32x16_bf16 v[4:19], v[64:67], a[128:131], v[4:19]
    ds_read_b64_tr_b16 v[52:53], v220 offset:16384
    ds_read_b64_tr_b16 v[54:55], v220 offset:18432
    s_waitcnt lgkmcnt(8)
    v_mfma_f32_32x32x16_bf16 v[4:19], v[68:71], a[132:135], v[4:19]
    ds_read_b64_tr_b16 v[56:57], v220 offset:20480
    ds_read_b64_tr_b16 v[58:59], v220 offset:22528
    s_waitcnt lgkmcnt(8)
    v_mfma_f32_32x32x16_bf16 v[4:19], v[72:75], a[136:139], v[4:19]
    ds_read_b64_tr_b16 v[60:61], v220 offset:24576
    ds_read_b64_tr_b16 v[62:63], v220 offset:26624
    s_waitcnt lgkmcnt(8)
    v_mfma_f32_32x32x16_bf16 v[4:19], v[76:79], a[140:143], v[4:19]
    ds_read_b64_tr_b16 v[64:65], v220 offset:28672
    ds_read_b64_tr_b16 v[66:67], v220 offset:30720
    s_waitcnt lgkmcnt(8)
    v_mfma_f32_32x32x16_bf16 v[4:19], v[80:83], a[144:147], v[4:19]
    ds_read_b64_tr_b16 v[68:69], v220 offset:32768
    ds_read_b64_tr_b16 v[70:71], v220 offset:34816
    s_waitcnt lgkmcnt(8)
    v_mfma_f32_32x32x16_bf16 v[4:19], v[52:55], a[148:151], v[4:19]
    ds_read_b64_tr_b16 v[72:73], v220 offset:36864
    ds_read_b64_tr_b16 v[74:75], v220 offset:38912
    s_waitcnt lgkmcnt(8)
    v_mfma_f32_32x32x16_bf16 v[4:19], v[56:59], a[152:155], v[4:19]
    ds_read_b64_tr_b16 v[76:77], v220 offset:40960
    ds_read_b64_tr_b16 v[78:79], v220 offset:43008
    s_waitcnt lgkmcnt(8)
    v_mfma_f32_32x32x16_bf16 v[4:19], v[60:63], a[156:159], v[4:19]
    ds_read_b64_tr_b16 v[80:81], v220 offset:45056
    ds_read_b64_tr_b16 v[82:83], v220 offset:47104
    s_waitcnt lgkmcnt(8)
    v_mfma_f32_32x32x16_bf16 v[4:19], v[64:67], a[160:163], v[4:19]
    ds_read_b64_tr_b16 v[52:53], v220 offset:49152
    ds_read_b64_tr_b16 v[54:55], v220 offset:51200
    s_waitcnt lgkmcnt(8)
    v_mfma_f32_32x32x16_bf16 v[4:19], v[68:71], a[164:167], v[4:19]
    ds_read_b64_tr_b16 v[56:57], v220 offset:53248
    ds_read_b64_tr_b16 v[58:59], v220 offset:55296
    s_waitcnt lgkmcnt(8)
    v_mfma_f32_32x32x16_bf16 v[4:19], v[72:75], a[168:171], v[4:19]
    ds_read_b64_tr_b16 v[60:61], v220 offset:57344
    ds_read_b64_tr_b16 v[62:63], v220 offset:59392
    s_waitcnt lgkmcnt(8)
    v_mfma_f32_32x32x16_bf16 v[4:19], v[76:79], a[172:175], v[4:19]
    ds_read_b64_tr_b16 v[64:65], v220 offset:61440
    ds_read_b64_tr_b16 v[66:67], v220 offset:63488
    s_waitcnt lgkmcnt(8)
    v_mfma_f32_32x32x16_bf16 v[4:19], v[80:83], a[176:179], v[4:19]
    ds_read_b64_tr_b16 v[68:69], v216 offset:0
    ds_read_b64_tr_b16 v[70:71], v216 offset:2048
    s_waitcnt lgkmcnt(8)
    v_mfma_f32_32x32x16_bf16 v[4:19], v[52:55], a[180:183], v[4:19]
    s_waitcnt vmcnt(0)
    s_add_u32 s45, s34, s49
    s_mov_b64 exec, 1
    s_cmp_eq_u32 s33, 0
    s_cbranch_scc1 L_wt_46
    buffer_store_dword v190, v191, s[28:31], s45 offen offset:2048
L_wb_47:
    s_mov_b64 exec, -1
    ds_read_b64_tr_b16 v[72:73], v216 offset:4096
    ds_read_b64_tr_b16 v[74:75], v216 offset:6144
    s_waitcnt lgkmcnt(8)
    v_mfma_f32_32x32x16_bf16 v[4:19], v[56:59], a[184:187], v[4:19]
    ds_read_b64_tr_b16 v[76:77], v216 offset:8192
    ds_read_b64_tr_b16 v[78:79], v216 offset:10240
    s_waitcnt lgkmcnt(8)
    v_mfma_f32_32x32x16_bf16 v[4:19], v[60:63], a[188:191], v[4:19]
    ds_read_b64_tr_b16 v[80:81], v216 offset:12288
    ds_read_b64_tr_b16 v[82:83], v216 offset:14336
    s_waitcnt lgkmcnt(8)
    v_mfma_f32_32x32x16_bf16 v[4:19], v[64:67], a[192:195], v[4:19]
    s_waitcnt lgkmcnt(6)
    v_mfma_f32_32x32x16_bf16 v[4:19], v[68:71], a[196:199], v[4:19]
    s_waitcnt lgkmcnt(4)
    v_mfma_f32_32x32x16_bf16 v[4:19], v[72:75], a[200:203], v[4:19]
    s_waitcnt lgkmcnt(2)
    v_mfma_f32_32x32x16_bf16 v[4:19], v[76:79], a[204:207], v[4:19]
    s_waitcnt lgkmcnt(0)
    v_mfma_f32_32x32x16_bf16 v[4:19], v[80:83], a[208:211], v[4:19]
    v_mfma_f32_32x32x16_bf16 v[4:19], v[44:47], v[20:23], v[4:19]
    v_mfma_f32_32x32x16_bf16 v[4:19], v[48:51], v[24:27], v[4:19]
    buffer_load_dword v189, v247, s[28:31], s49 offen offset:2048 sc1
    s_waitcnt vmcnt(0)
    v_cmp_ne_u32 vcc, s47, v189
    s_cbranch_vccnz L_slow_48
L_back_50:
    buffer_load_dwordx4 v[144:147], v240, s[28:31], s12 offen sc1
    buffer_load_dwordx4 v[148:151], v240, s[28:31], s12 offen offset:1024 sc1
    s_add_u32 s12, s12, 8192
    buffer_load_dwordx4 v[152:155], v240, s[28:31], s12 offen sc1
    buffer_load_dwordx4 v[156:159], v240, s[28:31], s12 offen offset:1024 sc1
    s_add_u32 s12, s12, 8192
    buffer_load_dwordx4 v[160:163], v240, s[28:31], s12 offen sc1
    buffer_load_dwordx4 v[164:167], v240, s[28:31], s12 offen offset:1024 sc1
    s_waitcnt vmcnt(5)
    v_mfma_f32_32x32x16_bf16 v[4:19], v[44:47], v[144:147], v[4:19]
    s_waitcnt vmcnt(4)
    v_mfma_f32_32x32x16_bf16 v[4:19], v[48:51], v[148:151], v[4:19]
    s_waitcnt vmcnt(3)
    v_mfma_f32_32x32x16_bf16 v[4:19], v[44:47], v[152:155], v[4:19]
    s_waitcnt vmcnt(2)
    v_mfma_f32_32x32x16_bf16 v[4:19], v[48:51], v[156:159], v[4:19]
    s_waitcnt vmcnt(1)
    v_mfma_f32_32x32x16_bf16 v[4:19], v[44:47], v[160:163], v[4:19]
    s_waitcnt vmcnt(0)
    v_mfma_f32_32x32x16_bf16 v[4:19], v[48:51], v[164:167], v[4:19]
    s_nop 11
    v_cvt_pk_bf16_f32 v52, v4, v5
    v_cvt_pk_bf16_f32 v53, v6, v7
    ds_write_b64 v241, v[52:53] offset:0
    v_cvt_pk_bf16_f32 v54, v8, v9
    v_cvt_pk_bf16_f32 v55, v10, v11
    ds_write_b64 v241, v[54:55] offset:16
    v_cvt_pk_bf16_f32 v56, v12, v13
    v_cvt_pk_bf16_f32 v57, v14, v15
    ds_write_b64 v241, v[56:57] offset:32
    v_cvt_pk_bf16_f32 v58, v16, v17
    v_cvt_pk_bf16_f32 v59, v18, v19
    ds_write_b64 v241, v[58:59] offset:48
    s_waitcnt lgkmcnt(0)
    ds_read_b128 v[60:63], v238
    ds_read_b128 v[64:67], v238 offset:1280
    s_waitcnt lgkmcnt(1)
    buffer_store_dwordx4 v[60:63], v215, s[8:11], s53 offen
    s_waitcnt lgkmcnt(0)
    buffer_store_dwordx4 v[64:67], v215, s[8:11], s64 offen
    s_or_b32 s41, s2, s3
    s_cmp_lg_u32 s41, 0
    s_cbranch_scc1 L_ep_51
    s_mov_b64 exec, 1
    buffer_store_dword v190, v191, s[28:31], 0 offen offset:0 sc1
    s_mov_b64 exec, -1
L_ep_51:
    s_endpgm
L_res_1:
    ds_read_b128 v[12:15], v236
    ds_read_b128 v[16:19], v237
    s_waitcnt lgkmcnt(0)
    s_branch L_resb_2
L_res_3:
    ds_read_b128 v[12:15], v236
    ds_read_b128 v[16:19], v237
    s_waitcnt lgkmcnt(0)
    s_branch L_resb_4
L_res_5:
    ds_read_b128 v[12:15], v236
    ds_read_b128 v[16:19], v237
    s_waitcnt lgkmcnt(0)
    s_branch L_resb_6
L_res_7:
    ds_read_b128 v[12:15], v236
    ds_read_b128 v[16:19], v237
    s_waitcnt lgkmcnt(0)
    s_branch L_resb_8
L_res_9:
    ds_read_b128 v[12:15], v236
    ds_read_b128 v[16:19], v237
    s_waitcnt lgkmcnt(0)
    s_branch L_resb_10
L_res_11:
    ds_read_b128 v[12:15], v236
    ds_read_b128 v[16:19], v237
    s_waitcnt lgkmcnt(0)
    s_branch L_resb_12
L_res_13:
    ds_read_b128 v[12:15], v236
    ds_read_b128 v[16:19], v237
    s_waitcnt lgkmcnt(0)
    s_branch L_resb_14
L_res_15:
    ds_read_b128 v[12:15], v236
    ds_read_b128 v[16:19], v237
    s_waitcnt lgkmcnt(0)
    s_branch L_resb_16
L_slow_17:
    s_mov_b32 s46, 40000
L_tl_18:
    s_mov_b64 exec, vcc
    buffer_load_dwordx4 v[192:195], v170, s[28:31], s75 offen sc1
    buffer_load_dwordx2 v[216:217], v218, s[28:31], s75 offen offset:8 sc1
    s_waitcnt vmcnt(0)
    s_mov_b64 exec, -1
    v_cmp_ne_u32 vcc, s47, v195
    v_cmp_ne_u32 s[60:61], s47, v217
    s_nop 0
    s_or_b64 vcc, vcc, s[60:61]
    s_cbranch_scc0 L_back_19
    s_sub_u32 s46, s46, 1
    s_cbranch_scc0 L_tl_18
    s_branch L_back_19
L_slow_20:
    s_mov_b32 s46, 40000
L_tl_21:
    s_mov_b64 exec, vcc
    buffer_load_dwordx4 v[132:135], v173, s[28:31], s72 offen sc1
    buffer_load_dwordx4 v[136:139], v173, s[28:31], s72 offen offset:2048 sc1
    s_waitcnt vmcnt(0)
    s_mov_b64 exec, -1
    v_cmp_ne_u32 vcc, s47, v135
    v_cmp_ne_u32 s[60:61], s47, v139
    s_nop 0
    s_or_b64 vcc, vcc, s[60:61]
    s_cbranch_scc0 L_back_22
    s_sub_u32 s46, s46, 1
    s_cbranch_scc0 L_tl_21
    s_branch L_back_22
L_slow_23:
    s_mov_b32 s46, 40000
L_tl_24:
    s_mov_b64 exec, vcc
    buffer_load_dwordx4 v[132:135], v173, s[28:31], s74 offen sc1
    buffer_load_dwordx4 v[136:139], v173, s[28:31], s74 offen offset:2048 sc1
    s_waitcnt vmcnt(0)
    s_mov_b64 exec, -1
    v_cmp_ne_u32 vcc, s47, v135
    v_cmp_ne_u32 s[60:61], s47, v139
    s_nop 0
    s_or_b64 vcc, vcc, s[60:61]
    s_cbranch_scc0 L_back_25
    s_sub_u32 s46, s46, 1
    s_cbranch_scc0 L_tl_24
    s_branch L_back_25
L_wt_26:
    buffer_store_dword v190, v191, s[28:31], s45 offen offset:0 sc1
    s_branch L_wb_27
L_slow_28:
    s_mov_b32 s46, 40000
L_tl_29:
    s_mov_b64 exec, vcc
    buffer_load_dword v189, v249, s[28:31], s49 offen offset:0 sc1
    s_waitcnt vmcnt(0)
    s_mov_b64 exec, -1
    v_cmp_ne_u32 vcc, s47, v189
    s_cbranch_vccz L_back_30
    s_sub_u32 s46, s46, 1
    s_cbranch_scc0 L_tl_29
    s_branch L_back_30
L_wt_31:
    buffer_store_dword v190, v191, s[28:31], s45 offen offset:512 sc1
    s_branch L_wb_32
L_slow_33:
    s_mov_b32 s46, 40000
L_tl_34:
    s_mov_b64 exec, vcc
    buffer_load_dword v189, v243, s[28:31], s49 offen offset:512 sc1
    s_waitcnt vmcnt(0)
    s_mov_b64 exec, -1
    v_cmp_ne_u32 vcc, s47, v189
    s_cbranch_vccz L_back_35
    s_sub_u32 s46, s46, 1
    s_cbranch_scc0 L_tl_34
    s_branch L_back_35
L_wt_36:
    buffer_store_dword v190, v191, s[28:31], s45 offen offset:1024 sc1
    s_branch L_wb_37
L_slow_38:
    s_mov_b32 s46, 40000
L_tl_39:
    s_mov_b64 exec, vcc
    buffer_load_dword v189, v243, s[28:31], s49 offen offset:1024 sc1
    s_waitcnt vmcnt(0)
    s_mov_b64 exec, -1
    v_cmp_ne_u32 vcc, s47, v189
    s_cbranch_vccz L_back_40
    s_sub_u32 s46, s46, 1
    s_cbranch_scc0 L_tl_39
    s_branch L_back_40
L_wt_41:
    buffer_store_dword v190, v191, s[28:31], s45 offen offset:1536 sc1
    s_branch L_wb_42
L_slow_43:
    s_mov_b32 s46, 40000
L_tl_44:
    s_mov_b64 exec, vcc
    buffer_load_dword v189, v243, s[28:31], s49 offen offset:1536 sc1
    s_waitcnt vmcnt(0)
    s_mov_b64 exec, -1
    v_cmp_ne_u32 vcc, s47, v189
    s_cbranch_vccz L_back_45
    s_sub_u32 s46, s46, 1
    s_cbranch_scc0 L_tl_44
    s_branch L_back_45
L_wt_46:
    buffer_store_dword v190, v191, s[28:31], s45 offen offset:2048 sc1
    s_branch L_wb_47
L_slow_48:
    s_mov_b32 s46, 40000
L_tl_49:
    s_mov_b64 exec, vcc
    buffer_load_dword v189, v247, s[28:31], s49 offen offset:2048 sc1
    s_waitcnt vmcnt(0)
    s_mov_b64 exec, -1
    v_cmp_ne_u32 vcc, s47, v189
    s_cbranch_vccz L_back_50
    s_sub_u32 s46, s46, 1
    s_cbranch_scc0 L_tl_49
    s_branch L_back_50
L_end:
    s_endpgm
.section .rodata,"a"
.p2align 6
.amdhsa_kernel sequential_preLN__linear_kernel_hedgehog__dense_activation_mish__prompt_kernel
  .amdhsa_next_free_vgpr 512
  .amdhsa_next_free_sgpr 102
  .amdhsa_accum_offset 256
  .amdhsa_group_segment_fixed_size 0
  .amdhsa_kernarg_size 88
  .amdhsa_user_sgpr_count 2
  .amdhsa_user_sgpr_kernarg_segment_ptr 1
  .amdhsa_system_sgpr_workgroup_id_x 1
.end_amdhsa_kernel
```
